```python
import torch

def _softmax(x, axis=-1):
    return torch.softmax(x, dim=axis)
def _gelu(x):
    return torch.nn.functional.gelu(x, approximate="tanh")
def _silu(x):
    return torch.nn.functional.silu(x)
def _sigmoid(x):
    return torch.sigmoid(x)
def _layernorm(x, axis=-1, eps=1e-5):
    m = x.mean(dim=axis, keepdim=True)
    v = x.var(dim=axis, keepdim=True, unbiased=False)
    return (x - m) / torch.sqrt(v + eps)
def _scatter_add(tgt, idx, src, axis=0):
    return tgt.clone().index_add_(axis, idx, src)
def _segment_sum(src, seg, n):
    out = torch.zeros((n,) + src.shape[1:], dtype=src.dtype)
    return out.index_add_(0, seg, src)
def _pad(x, pw):
    flat = tuple(v for pair in reversed(pw) for v in pair)
    return torch.nn.functional.pad(x, flat)

kernel_name = 'gated_mix__sliding_block__sliding_local_dilated__prompt'

def setup_inputs():

    _w = (lambda a: (lambda t: t.to(torch.bfloat16) if t.is_floating_point() else t)(torch.as_tensor(a)))
    def _A_setup():
        B, S, D = 1, 2048, 512
        return {
            "x": _w((lambda *s: torch.randn(*s, dtype=torch.bfloat16) * 0.05)(B, S, D)),
            "wqkv": _w((lambda *s: torch.randn(*s, dtype=torch.bfloat16) * 1.6)(D, 3 * D)),
            "wo": _w((lambda *s: torch.randn(*s, dtype=torch.bfloat16) * 0.05)(D, D)),
        }
    _A_in = _A_setup()

    def _B_setup():
        B, S, D = 1, 2048, 512
        return {
            "x": _w((lambda *s: torch.randn(*s, dtype=torch.bfloat16) * 0.05)(B, S, D)),
            "wqkv": _w((lambda *s: torch.randn(*s, dtype=torch.bfloat16) * 1.6)(D, 3 * D)),
            "wo": _w((lambda *s: torch.randn(*s, dtype=torch.bfloat16) * 0.05)(D, D)),
        }
    _B_in = _B_setup()

    return {
        "A_x": _A_in["x"],
        "A_wqkv": _A_in["wqkv"],
        "A_wo": _A_in["wo"],
        "B_x": _B_in["x"],
        "B_wqkv": _B_in["wqkv"],
        "B_wo": _B_in["wo"],
        "gate_w": _w((lambda *s: torch.randn(*s, dtype=torch.bfloat16) * 0.05)(512) * 16.0),
    }

def reference(A_x, A_wqkv, A_wo, B_x, B_wqkv, B_wo, gate_w):
    def _A_ref(x, wqkv, wo):
        B, S, D = x.shape
        H = 32; Dh = D // H; W = 256
        qkv = (lambda x, *d: x.permute(*d))((x @ wqkv).reshape(B, S, 3, H, Dh), 2, 0, 3, 1, 4)
        q, k, v = qkv[0], qkv[1], qkv[2]
        scores = torch.einsum("bhqd,bhkd->bhqk", q, k) * (Dh ** -0.5)
        idx = torch.arange(S)
        mask = (idx[:, None] - idx[None, :] >= 0) & (idx[:, None] - idx[None, :] < W)
        scores = torch.where(mask[None, None], scores, -1e9)
        p = _softmax(scores, axis=-1)
        o = torch.einsum("bhqk,bhkd->bhqd", p, v)
        return (lambda x, *d: x.permute(*d))(o, 0, 2, 1, 3).reshape(B, S, D) @ wo

    def _B_ref(x, wqkv, wo):
        B, S, D = x.shape
        H = 32; Dh = D // H
        W, dil = 8, 2
        qkv = (lambda x, *d: x.permute(*d))((x @ wqkv).reshape(B, S, 3, H, Dh), 2, 0, 3, 1, 4)
        q, k, v = qkv[0], qkv[1], qkv[2]
        scale = Dh ** -0.5
        pos = torch.arange(S)
        off = torch.arange(W) * dil
        idx = pos[:, None] - off[None, :]
        mask = idx >= 0
        idx_c = torch.where(mask, idx, 0).reshape(-1)
        kg = k[:, :, idx_c, :].reshape(B, H, S, W, Dh)
        vg = v[:, :, idx_c, :].reshape(B, H, S, W, Dh)
        logits = torch.einsum("bhsd,bhswd->bhsw", q, kg) * scale
        logits = torch.where(mask[None, None, :, :], logits, -1e9)
        attn = _softmax(logits, axis=-1)
        o = torch.einsum("bhsw,bhswd->bhsd", attn, vg)
        return (lambda x, *d: x.permute(*d))(o, 0, 2, 1, 3).reshape(B, S, D) @ wo

    x = A_x
    g = _sigmoid((x * gate_w).sum(-1, keepdims=True))
    a = _A_ref(x, A_wqkv, A_wo)
    b = _B_ref(x, B_wqkv, B_wo)
    return g * a + (1 - g) * b
```

```asm
; @launch grid=(256,1,1) block=(256,1,1) lds=152576
.amdgcn_target "amdgcn-amd-amdhsa--gfx950"
.text
.globl gated_mix__sliding_block__sliding_local_dilated__prompt_kernel
.p2align 8
.type gated_mix__sliding_block__sliding_local_dilated__prompt_kernel,@function
gated_mix__sliding_block__sliding_local_dilated__prompt_kernel:
    s_cmp_ge_u32 s2, 256
    s_cbranch_scc1 L_end
    s_load_dwordx2 s[4:5], s[0:1], 0
    s_load_dwordx2 s[12:13], s[0:1], 8
    s_load_dwordx2 s[20:21], s[0:1], 48
    s_load_dwordx2 s[8:9], s[0:1], 0
    s_load_dwordx2 s[16:17], s[0:1], 8
    s_load_dwordx2 s[28:29], s[0:1], 32
    s_load_dwordx2 s[32:33], s[0:1], 16
    s_load_dwordx2 s[36:37], s[0:1], 40
    s_load_dwordx2 s[44:45], s[0:1], 56
    s_load_dwordx2 s[24:25], s[0:1], 64
    s_load_dwordx2 s[40:41], s[0:1], 72
    s_getpc_b64 s[52:53]
L_pc:
    v_lshrrev_b32 v2, 6, v0
    v_and_b32 v1, 63, v0
    s_lshr_b32 s71, s2, 3
    s_sub_u32 s52, s52, L_pc-gated_mix__sliding_block__sliding_local_dilated__prompt_kernel
    s_subb_u32 s53, s53, 0
    s_mov_b32 s54, L_end-gated_mix__sliding_block__sliding_local_dilated__prompt_kernel
    s_mov_b32 s55, 0x20000
    s_mul_i32 s72, s71, 1024
    v_mad_u32_u24 v4, v2, 2, v1
    v_lshlrev_b32 v4, 7, v4
    s_mov_b64 exec, 3
    buffer_load_dword v44, v4, s[52:55], s72 offen
    s_mov_b64 exec, -1
    v_readfirstlane_b32 s67, v2
    s_and_b32 s64, s71, 3
    s_lshl_b32 s73, s64, 8
    s_and_b32 s72, s2, 1
    s_lshl_b32 s72, s72, 2
    s_add_u32 s64, s64, s72
    s_lshr_b32 s65, s71, 2
    s_bfe_u32 s72, s2, 0x20001
    s_lshl_b32 s72, s72, 3
    s_add_u32 s66, s65, s72
    v_lshrrev_b32 v3, 3, v1
    v_and_b32 v4, 7, v1
    v_bfe_u32 v5, v1, 4, 1
    v_and_b32 v25, 15, v1
    v_lshl_add_u32 v25, v2, 4, v25
    v_lshlrev_b32 v25, 10, v25
    v_lshl_add_u32 v25, v5, 7, v25
    v_and_b32 v8, 1, v2
    v_lshl_or_b32 v5, v8, 1, v5
    v_lshlrev_b32 v5, 1, v5
    v_xor_b32 v5, v5, v4
    v_lshl_add_u32 v8, v2, 3, v3
    v_mul_u32_u24 v8, 3072, v8
    v_lshl_add_u32 v8, v5, 4, v8
    s_lshl_b32 s93, s67, 11
    v_add_u32 v0, 98304, v8
    s_mul_i32 s76, s65, 196608
    s_lshl_b32 s56, s66, 16
    s_lshl_b32 s57, s64, 7
    s_add_u32 s75, s57, 1024
    s_sub_u32 s6, 2097152, s56
    s_mov_b32 s7, 0x20000
    s_sub_u32 s14, 1572864, s75
    s_mov_b32 s15, 0x20000
    s_waitcnt lgkmcnt(0)
    s_add_u32 s4, s4, s56
    s_addc_u32 s5, s5, 0
    s_add_u32 s12, s12, s75
    s_addc_u32 s13, s13, 0
    s_mov_b32 exec_hi, 0
    buffer_load_dword v44, v25, s[4:7], s73 offen
    s_mov_b64 exec, -1
    s_add_u32 m0, s93, 65536
    s_nop 0
    buffer_load_dwordx4 v8, s[12:15], s76 offen offset:0 lds
    buffer_load_dwordx4 v8, s[12:15], s76 offen offset:1024 lds
    s_add_u32 m0, s93, 73728
    s_nop 0
    buffer_load_dwordx4 v0, s[12:15], s76 offen offset:0 lds
    buffer_load_dwordx4 v0, s[12:15], s76 offen offset:1024 lds
    v_lshrrev_b32 v7, 1, v2
    v_lshlrev_b32 v7, 5, v7
    v_and_or_b32 v7, v2, 1, v7
    v_lshl_add_u32 v7, v3, 1, v7
    v_lshrrev_b32 v5, 4, v1
    v_xor_b32 v5, v5, v4
    v_lshlrev_b32 v5, 4, v5
    v_lshl_add_u32 v6, v7, 10, v5
    v_lshl_add_u32 v9, v3, 10, v5
    v_xor_b32 v7, 64, v6
    v_add_u32 v7, 15360, v7
    v_xor_b32 v10, 64, v9
    v_add_u32 v10, 7168, v10
    v_lshlrev_b32 v20, 4, v1
    s_lshl_b32 s71, s65, 7
    v_add_u32 v11, s71, v20
    v_and_b32 v11, 1023, v11
    s_lshl_b32 s92, s67, 10
    s_mul_i32 s94, s67, 3072
    s_lshl_b32 s95, s67, 12
    s_xor_b32 s69, s64, 1
    s_xor_b32 s70, s64, 2
    s_add_u32 s71, s65, 0
    s_and_b32 s71, s71, 7
    s_lshl_b32 s84, s71, 7
    s_add_u32 s71, s65, 1
    s_and_b32 s71, s71, 7
    s_lshl_b32 s85, s71, 7
    s_mul_i32 s77, s71, 196608
    s_add_u32 s71, s65, 2
    s_and_b32 s71, s71, 7
    s_lshl_b32 s86, s71, 7
    s_mul_i32 s78, s71, 196608
    s_add_u32 s71, s65, 3
    s_and_b32 s71, s71, 7
    s_lshl_b32 s87, s71, 7
    s_mul_i32 s79, s71, 196608
    s_add_u32 s71, s65, 4
    s_and_b32 s71, s71, 7
    s_lshl_b32 s88, s71, 7
    s_mul_i32 s80, s71, 196608
    s_add_u32 s71, s65, 5
    s_and_b32 s71, s71, 7
    s_lshl_b32 s89, s71, 7
    s_mul_i32 s81, s71, 196608
    s_add_u32 s71, s65, 6
    s_and_b32 s71, s71, 7
    s_lshl_b32 s90, s71, 7
    s_mul_i32 s82, s71, 196608
    s_add_u32 s71, s65, 7
    s_and_b32 s71, s71, 7
    s_lshl_b32 s91, s71, 7
    s_mul_i32 s83, s71, 196608
    s_mov_b32 s22, 1024
    s_mov_b32 s23, 0x20000
    s_add_u32 s16, s16, s57
    s_addc_u32 s17, s17, 0
    s_sub_u32 s18, 1572864, s57
    s_mov_b32 s19, 0x20000
    s_lshl_b32 s71, s69, 7
    s_add_u32 s28, s28, s71
    s_addc_u32 s29, s29, 0
    s_sub_u32 s30, 1572864, s71
    s_mov_b32 s31, 0x20000
    s_lshl_b32 s71, s70, 7
    s_add_u32 s32, s32, s71
    s_addc_u32 s33, s33, 0
    s_sub_u32 s34, 524288, s71
    s_mov_b32 s35, 0x20000
    s_add_u32 s36, s36, s71
    s_addc_u32 s37, s37, 0
    s_sub_u32 s38, 524288, s71
    s_mov_b32 s39, 0x20000
    s_add_u32 s71, s71, s56
    s_add_u32 s44, s44, s71
    s_addc_u32 s45, s45, 0
    s_sub_u32 s46, 2097152, s71
    s_mov_b32 s47, 0x20000
    s_sub_u32 s71, s56, 16384
    s_max_i32 s71, s71, 0
    s_add_u32 s8, s8, s71
    s_addc_u32 s9, s9, 0
    s_sub_u32 s10, 2097152, s71
    s_mov_b32 s11, 0x20000
    s_lshl_b32 s71, s67, 1
    s_add_u32 s71, s71, s65
    s_and_b32 s74, s71, 7
    s_lshl_b32 s74, s74, 7
    s_add_u32 s71, s71, 1
    s_and_b32 s71, s71, 7
    s_lshl_b32 s70, s71, 7
    s_mov_b32 s42, 33554432
    s_mov_b32 s43, 0x20000
    s_mov_b32 s26, 256
    s_mov_b32 s27, 0x20000
    s_or_b32 s71, s67, s2
    s_cbranch_scc1 L_notag
    s_memrealtime s[52:53]
    v_mov_b32 v4, 0
    s_waitcnt lgkmcnt(0)
    v_mov_b32 v132, s52
    v_mov_b32 v133, s53
    s_mov_b64 exec, 1
    buffer_store_dwordx2 v[132:133], v4, s[24:27], 0 offen sc1
    s_mov_b64 exec, -1
L_notag:
    s_lshl_b32 s68, s64, 2
    s_add_u32 s68, s68, s67
    s_lshl_b32 s71, s66, 5
    s_add_u32 s71, s71, s68
    s_mul_i32 s96, s66, 135168
    s_lshl_b32 s72, s68, 12
    s_add_u32 s96, s96, s72
    s_lshl_b32 s97, s68, 9
    s_lshl_b32 s72, s66, 3
    s_add_u32 s97, s97, s72
    s_add_u32 s97, s97, 32
    s_add_u32 s97, s97, 11534336
    s_mov_b32 s62, 0xffff
    s_mov_b32 s63, 0xffff
    s_mul_i32 s71, s66, 69632
    s_lshl_b32 s72, s68, 10
    s_add_u32 s98, s71, s72
    s_add_u32 s98, s98, 5242880
    s_lshl_b32 s72, s69, 2
    s_add_u32 s69, s72, s67
    s_lshl_b32 s72, s69, 10
    s_add_u32 s99, s71, s72
    s_add_u32 s99, s99, 8388608
    s_movk_i32 s71, 1280
    v_lshrrev_b32 v128, 4, v1
    v_bfe_u32 v129, v1, 2, 2
    v_and_b32 v130, 3, v1
    v_and_b32 v131, 15, v1
    v_bfe_u32 v3, v1, 3, 2
    v_xor_b32 v4, v3, v2
    v_lshlrev_b32 v4, 5, v4
    v_lshl_add_u32 v4, v130, 3, v4
    v_lshl_add_u32 v4, v129, 7, v4
    v_lshl_add_u32 v13, v128, 10, v4
    v_lshl_add_u32 v12, v128, 11, v4
    v_lshl_add_u32 v14, v128, 10, v12
    v_add_u32 v37, 65536, v13
    v_add_u32 v36, 65536, v12
    v_add_u32 v32, 65536, v14
    v_lshrrev_b32 v4, 1, v131
    v_xor_b32 v4, v4, v128
    v_lshlrev_b32 v4, 4, v4
    v_lshl_add_u32 v15, v131, 7, v4
    v_xor_b32 v16, 64, v15
    v_add_u32 v17, 131072, v15
    v_add_u32 v18, 131072, v16
    v_lshlrev_b32 v19, 4, v128
    v_mad_u32_u24 v19, v2, s71, v19
    v_add_u32 v19, 147456, v19
    v_lshrrev_b32 v3, 3, v1
    v_and_b32 v4, 7, v1
    v_xor_b32 v5, 0, v3
    v_lshlrev_b32 v5, 12, v5
    v_lshl_add_u32 v5, v2, 15, v5
    v_xor_b32 v26, 0, v4
    v_lshl_add_u32 v26, v26, 4, v5
    v_xor_b32 v5, 1, v3
    v_lshlrev_b32 v5, 12, v5
    v_lshl_add_u32 v5, v2, 15, v5
    v_xor_b32 v27, 0, v4
    v_lshl_add_u32 v27, v27, 4, v5
    v_xor_b32 v5, 0, v3
    v_lshlrev_b32 v5, 12, v5
    v_lshl_add_u32 v5, v2, 15, v5
    v_xor_b32 v28, 4, v4
    v_lshl_add_u32 v28, v28, 4, v5
    v_xor_b32 v5, 1, v3
    v_lshlrev_b32 v5, 12, v5
    v_lshl_add_u32 v5, v2, 15, v5
    v_xor_b32 v29, 4, v4
    v_lshl_add_u32 v29, v29, 4, v5
    v_lshrrev_b32 v3, 5, v1
    v_and_b32 v5, 1, v2
    v_xor_b32 v4, v3, v129
    v_and_b32 v4, 1, v4
    v_lshlrev_b32 v30, 7, v4
    v_lshl_add_u32 v30, v129, 10, v30
    v_lshl_add_u32 v30, v5, 13, v30
    v_lshl_add_u32 v30, v130, 3, v30
    v_and_b32 v4, 1, v128
    v_lshl_add_u32 v30, v4, 5, v30
    v_lshrrev_b32 v22, 1, v129
    v_xor_b32 v22, v22, v5
    v_lshl_add_u32 v30, v22, 6, v30
    v_xor_b32 v31, 64, v30
    v_lshlrev_b32 v21, 4, v131
    v_lshl_add_u32 v21, v3, 8, v21
    v_lshl_add_u32 v23, v131, 1, v4
    v_lshrrev_b32 v22, 1, v2
    v_lshl_add_u32 v23, v22, 5, v23
    v_lshlrev_b32 v23, 10, v23
    v_lshl_add_u32 v23, v5, 6, v23
    v_lshl_add_u32 v23, v3, 4, v23
    v_lshl_add_u32 v22, v2, 12, v20
    v_add_u32 v22, 131072, v22
    v_mov_b32 v24, 4286578688
    v_and_b32 v5, 11, v1
    v_cmp_eq_u32 s[60:61], 0, v5
    v_mov_b32 v5, 1065369472
    s_nop 0
    v_cndmask_b32 v33, 0, v5, s[60:61]
    v_and_b32 v4, 1, v128
    v_lshl_add_u32 v4, v131, 1, v4
    v_lshlrev_b32 v3, 3, v3
    v_sub_u32 v4, v4, v3
    v_cmp_le_i32 s[60:61], 0, v4
    s_nop 1
    v_cndmask_b32 v48, v24, 0, s[60:61]
    v_cndmask_b32 v64, 0, v24, s[60:61]
    v_cmp_le_i32 s[60:61], 2, v4
    s_nop 1
    v_cndmask_b32 v49, v24, 0, s[60:61]
    v_cndmask_b32 v65, 0, v24, s[60:61]
    v_cmp_le_i32 s[60:61], 4, v4
    s_nop 1
    v_cndmask_b32 v50, v24, 0, s[60:61]
    v_cndmask_b32 v66, 0, v24, s[60:61]
    v_cmp_le_i32 s[60:61], 6, v4
    s_nop 1
    v_cndmask_b32 v51, v24, 0, s[60:61]
    v_cndmask_b32 v67, 0, v24, s[60:61]
    v_cmp_le_i32 s[60:61], 16, v4
    s_nop 1
    v_cndmask_b32 v52, v24, 0, s[60:61]
    v_cndmask_b32 v68, 0, v24, s[60:61]
    v_cmp_le_i32 s[60:61], 18, v4
    s_nop 1
    v_cndmask_b32 v53, v24, 0, s[60:61]
    v_cndmask_b32 v69, 0, v24, s[60:61]
    v_cmp_le_i32 s[60:61], 20, v4
    s_nop 1
    v_cndmask_b32 v54, v24, 0, s[60:61]
    v_cndmask_b32 v70, 0, v24, s[60:61]
    v_cmp_le_i32 s[60:61], 22, v4
    s_nop 1
    v_cndmask_b32 v55, v24, 0, s[60:61]
    v_cndmask_b32 v71, 0, v24, s[60:61]
    v_cmp_le_i32 s[60:61], 1, v4
    s_nop 1
    v_cndmask_b32 v56, v24, 0, s[60:61]
    v_cndmask_b32 v72, 0, v24, s[60:61]
    v_cmp_le_i32 s[60:61], 3, v4
    s_nop 1
    v_cndmask_b32 v57, v24, 0, s[60:61]
    v_cndmask_b32 v73, 0, v24, s[60:61]
    v_cmp_le_i32 s[60:61], 5, v4
    s_nop 1
    v_cndmask_b32 v58, v24, 0, s[60:61]
    v_cndmask_b32 v74, 0, v24, s[60:61]
    v_cmp_le_i32 s[60:61], 7, v4
    s_nop 1
    v_cndmask_b32 v59, v24, 0, s[60:61]
    v_cndmask_b32 v75, 0, v24, s[60:61]
    v_cmp_le_i32 s[60:61], 17, v4
    s_nop 1
    v_cndmask_b32 v60, v24, 0, s[60:61]
    v_cndmask_b32 v76, 0, v24, s[60:61]
    v_cmp_le_i32 s[60:61], 19, v4
    s_nop 1
    v_cndmask_b32 v61, v24, 0, s[60:61]
    v_cndmask_b32 v77, 0, v24, s[60:61]
    v_cmp_le_i32 s[60:61], 21, v4
    s_nop 1
    v_cndmask_b32 v62, v24, 0, s[60:61]
    v_cndmask_b32 v78, 0, v24, s[60:61]
    v_cmp_le_i32 s[60:61], 23, v4
    s_nop 1
    v_cndmask_b32 v63, v24, 0, s[60:61]
    v_cndmask_b32 v79, 0, v24, s[60:61]
    v_lshlrev_b32 v3, 2, v128
    v_sub_u32 v4, v131, v3
    v_add_u32 v5, v4, v131
    s_cmp_eq_u32 s66, 0
    s_cselect_b32 s71, 64, 0
    v_add_u32 v5, s71, v5
    v_subrev_u32 v3, 0, v4
    v_cmp_ge_u32 s[60:61], 7, v3
    s_nop 1
    v_cndmask_b32 v80, v24, 0, s[60:61]
    v_cmp_ge_i32 s[60:61], -9, v3
    s_nop 1
    v_cndmask_b32 v84, v24, 0, s[60:61]
    v_cmp_ge_i32 s[60:61], -2, v5
    s_nop 1
    v_cndmask_b32 v88, v24, 0, s[60:61]
    v_mov_b32 v92, v24
    v_subrev_u32 v3, 1, v4
    v_cmp_ge_u32 s[60:61], 7, v3
    s_nop 1
    v_cndmask_b32 v81, v24, 0, s[60:61]
    v_cmp_ge_i32 s[60:61], -9, v3
    s_nop 1
    v_cndmask_b32 v85, v24, 0, s[60:61]
    v_cmp_ge_i32 s[60:61], -2, v5
    s_nop 1
    v_cndmask_b32 v93, v24, 0, s[60:61]
    v_mov_b32 v89, v24
    v_subrev_u32 v3, 2, v4
    v_cmp_ge_u32 s[60:61], 7, v3
    s_nop 1
    v_cndmask_b32 v82, v24, 0, s[60:61]
    v_cmp_ge_i32 s[60:61], -9, v3
    s_nop 1
    v_cndmask_b32 v86, v24, 0, s[60:61]
    v_cmp_ge_i32 s[60:61], 0, v5
    s_nop 1
    v_cndmask_b32 v90, v24, 0, s[60:61]
    v_mov_b32 v94, v24
    v_subrev_u32 v3, 3, v4
    v_cmp_ge_u32 s[60:61], 7, v3
    s_nop 1
    v_cndmask_b32 v83, v24, 0, s[60:61]
    v_cmp_ge_i32 s[60:61], -9, v3
    s_nop 1
    v_cndmask_b32 v87, v24, 0, s[60:61]
    v_cmp_ge_i32 s[60:61], 0, v5
    s_nop 1
    v_cndmask_b32 v95, v24, 0, s[60:61]
    v_mov_b32 v91, v24
    v_mov_b32 v200, 0
    v_mov_b32 v201, 0
    v_mov_b32 v202, 0
    v_mov_b32 v203, 0
    v_mov_b32 v204, 0
    v_mov_b32 v205, 0
    v_mov_b32 v206, 0
    v_mov_b32 v207, 0
    v_mov_b32 v208, 0
    v_mov_b32 v209, 0
    v_mov_b32 v210, 0
    v_mov_b32 v211, 0
    v_mov_b32 v212, 0
    v_mov_b32 v213, 0
    v_mov_b32 v214, 0
    v_mov_b32 v215, 0
    v_mov_b32 v106, v33
    v_mov_b32 v107, v33
    v_mov_b32 v110, v33
    v_mov_b32 v111, v33
    v_mov_b32 v114, v33
    v_mov_b32 v115, v33
    v_mov_b32 v118, v33
    v_mov_b32 v119, v33
    s_mov_b32 s75, 0
    v_lshlrev_b32 v3, 7, v1
    v_and_b32 v4, 15, v1
    v_lshlrev_b32 v4, 4, v4
    v_add_u32 v4, 151552, v4
    v_lshl_add_u32 v5, v2, 2, v4
    s_mov_b32 s60, 0x11111111
    s_mov_b32 s61, 0x11111111
    s_add_u32 m0, s93, 0
    s_nop 0
    buffer_load_dwordx4 v6, s[4:7], s84 offen lds
    buffer_load_dwordx4 v7, s[4:7], s84 offen offset:1024 lds
    s_add_u32 m0, s93, 81920
    s_nop 0
    buffer_load_dwordx4 v8, s[12:15], s77 offen offset:0 lds
    buffer_load_dwordx4 v8, s[12:15], s77 offen offset:1024 lds
    s_add_u32 m0, s93, 90112
    s_nop 0
    buffer_load_dwordx4 v0, s[12:15], s77 offen offset:0 lds
    buffer_load_dwordx4 v0, s[12:15], s77 offen offset:1024 lds
    s_add_u32 m0, s93, 8192
    s_nop 0
    buffer_load_dwordx4 v6, s[4:7], s85 offen lds
    buffer_load_dwordx4 v7, s[4:7], s85 offen offset:1024 lds
    s_add_u32 m0, s92, 147456
    s_nop 0
    buffer_load_dwordx4 v11, s[20:23], 0 offen lds
    s_add_u32 m0, s93, 16384
    s_nop 0
    buffer_load_dwordx4 v6, s[4:7], s86 offen lds
    buffer_load_dwordx4 v7, s[4:7], s86 offen offset:1024 lds
    s_add_u32 m0, s93, 98304
    s_nop 0
    buffer_load_dwordx4 v8, s[12:15], s78 offen offset:0 lds
    buffer_load_dwordx4 v8, s[12:15], s78 offen offset:1024 lds
    s_add_u32 m0, s93, 24576
    s_nop 0
    buffer_load_dwordx4 v6, s[4:7], s87 offen lds
    buffer_load_dwordx4 v7, s[4:7], s87 offen offset:1024 lds
    s_add_u32 m0, s93, 106496
    s_nop 0
    buffer_load_dwordx4 v0, s[12:15], s78 offen offset:0 lds
    buffer_load_dwordx4 v0, s[12:15], s78 offen offset:1024 lds
    s_add_u32 m0, s93, 32768
    s_nop 0
    buffer_load_dwordx4 v6, s[4:7], s88 offen lds
    s_waitcnt vmcnt(16)
    s_barrier
    ds_read_b64_tr_b16 v[144:145], v36 offset:0
    ds_read_b64_tr_b16 v[146:147], v36 offset:512
    ds_read_b128 a[0:3], v15 offset:0
    ds_read_b64_tr_b16 v[148:149], v36 offset:1024
    ds_read_b64_tr_b16 v[150:151], v36 offset:1536
    ds_read_b128 a[4:7], v15 offset:2048
    ds_read_b128 a[8:11], v15 offset:4096
    ds_read_b128 a[12:15], v15 offset:6144
    ds_read_b64_tr_b16 v[152:153], v36 offset:8192
    ds_read_b64_tr_b16 v[154:155], v36 offset:8704
    ds_read_b64_tr_b16 v[156:157], v36 offset:9216
    ds_read_b64_tr_b16 v[158:159], v36 offset:9728
    ds_read_b128 a[16:19], v16 offset:0
    ds_read_b128 a[20:23], v16 offset:2048
    ds_read_b128 a[24:27], v16 offset:4096
    ds_read_b128 a[28:31], v16 offset:6144
    buffer_load_dwordx4 v7, s[4:7], s88 offen offset:1024 lds
    s_add_u32 m0, s93, 114688
    s_nop 0
    buffer_load_dwordx4 v8, s[12:15], s79 offen offset:0 lds
    buffer_load_dwordx4 v8, s[12:15], s79 offen offset:1024 lds
    s_add_u32 m0, s93, 40960
    s_nop 0
    buffer_load_dwordx4 v6, s[4:7], s89 offen lds
    buffer_load_dwordx4 v7, s[4:7], s89 offen offset:1024 lds
    s_add_u32 m0, s93, 122880
    s_nop 0
    buffer_load_dwordx4 v0, s[12:15], s79 offen offset:0 lds
    s_waitcnt vmcnt(16)
    s_barrier
    s_waitcnt lgkmcnt(13)
    v_mfma_f32_16x16x32_bf16 v[128:131], v[144:147], a[0:3], 0
    ds_read_b64_tr_b16 v[160:161], v36 offset:16384
    ds_read_b64_tr_b16 v[162:163], v36 offset:16896
    buffer_load_dwordx4 v0, s[12:15], s79 offen offset:1024 lds
    s_waitcnt lgkmcnt(13)
    v_mfma_f32_16x16x32_bf16 v[168:171], a[0:3], v[148:151], 0
    ds_read_b64_tr_b16 v[164:165], v36 offset:17408
    ds_read_b64_tr_b16 v[166:167], v36 offset:17920
    s_add_u32 m0, s93, 49152
    s_waitcnt lgkmcnt(14)
    v_mfma_f32_16x16x32_bf16 v[132:135], v[144:147], a[4:7], 0
    ds_read_b128 a[32:35], v15 offset:8192
    buffer_load_dwordx4 v6, s[4:7], s90 offen lds
    v_mfma_f32_16x16x32_bf16 v[172:175], a[4:7], v[148:151], 0
    ds_read_b128 a[36:39], v15 offset:10240
    s_waitcnt lgkmcnt(15)
    v_mfma_f32_16x16x32_bf16 v[136:139], v[144:147], a[8:11], 0
    ds_read_b128 a[40:43], v15 offset:12288
    v_mfma_f32_16x16x32_bf16 v[176:179], a[8:11], v[148:151], 0
    ds_read_b128 a[44:47], v15 offset:14336
    buffer_load_dwordx4 v7, s[4:7], s90 offen offset:1024 lds
    s_waitcnt lgkmcnt(15)
    v_mfma_f32_16x16x32_bf16 v[140:143], v[144:147], a[12:15], 0
    ds_read_b128 a[48:51], v16 offset:8192
    v_mfma_f32_16x16x32_bf16 v[180:183], a[12:15], v[148:151], 0
    ds_read_b128 a[52:55], v16 offset:10240
    s_waitcnt vmcnt(16) lgkmcnt(10)
    s_barrier
    s_add_u32 m0, s93, 65536
    v_mfma_f32_16x16x32_bf16 v[128:131], v[152:155], a[16:19], v[128:131]
    ds_read_b64_tr_b16 v[144:145], v36 offset:24576
    ds_read_b64_tr_b16 v[146:147], v36 offset:25088
    buffer_load_dwordx4 v8, s[12:15], s80 offen offset:0 lds
    v_mfma_f32_16x16x32_bf16 v[168:171], a[16:19], v[156:159], v[168:171]
    ds_read_b64_tr_b16 v[148:149], v36 offset:25600
    ds_read_b64_tr_b16 v[150:151], v36 offset:26112
    v_mfma_f32_16x16x32_bf16 v[132:135], v[152:155], a[20:23], v[132:135]
    ds_read_b128 a[56:59], v16 offset:12288
    buffer_load_dwordx4 v8, s[12:15], s80 offen offset:1024 lds
    v_mfma_f32_16x16x32_bf16 v[172:175], a[20:23], v[156:159], v[172:175]
    ds_read_b128 a[60:63], v16 offset:14336
    v_mfma_f32_16x16x32_bf16 v[136:139], v[152:155], a[24:27], v[136:139]
    ds_read_b128 a[64:67], v15 offset:16384
    s_add_u32 m0, s93, 57344
    v_mfma_f32_16x16x32_bf16 v[176:179], a[24:27], v[156:159], v[176:179]
    ds_read_b128 a[68:71], v15 offset:18432
    buffer_load_dwordx4 v6, s[4:7], s91 offen lds
    v_mfma_f32_16x16x32_bf16 v[140:143], v[152:155], a[28:31], v[140:143]
    ds_read_b128 a[72:75], v15 offset:20480
    v_mfma_f32_16x16x32_bf16 v[180:183], a[28:31], v[156:159], v[180:183]
    ds_read_b128 a[76:79], v15 offset:22528
    s_waitcnt vmcnt(15) lgkmcnt(12)
    s_barrier
    v_mfma_f32_16x16x32_bf16 v[128:131], v[160:163], a[32:35], v[128:131]
    ds_read_b64_tr_b16 v[152:153], v36 offset:32768
    ds_read_b64_tr_b16 v[154:155], v36 offset:33280
    buffer_load_dwordx4 v7, s[4:7], s91 offen offset:1024 lds
    v_mfma_f32_16x16x32_bf16 v[168:171], a[32:35], v[164:167], v[168:171]
    ds_read_b64_tr_b16 v[156:157], v36 offset:33792
    ds_read_b64_tr_b16 v[158:159], v36 offset:34304
    s_add_u32 m0, s93, 73728
    v_mfma_f32_16x16x32_bf16 v[132:135], v[160:163], a[36:39], v[132:135]
    ds_read_b128 a[80:83], v16 offset:16384
    buffer_load_dwordx4 v0, s[12:15], s80 offen offset:0 lds
    v_mfma_f32_16x16x32_bf16 v[172:175], a[36:39], v[164:167], v[172:175]
    ds_read_b128 a[84:87], v16 offset:18432
    v_mfma_f32_16x16x32_bf16 v[136:139], v[160:163], a[40:43], v[136:139]
    ds_read_b128 a[88:91], v16 offset:20480
    v_mfma_f32_16x16x32_bf16 v[176:179], a[40:43], v[164:167], v[176:179]
    ds_read_b128 a[92:95], v16 offset:22528
    buffer_load_dwordx4 v0, s[12:15], s80 offen offset:1024 lds
    v_mfma_f32_16x16x32_bf16 v[140:143], v[160:163], a[44:47], v[140:143]
    ds_read_b128 a[96:99], v15 offset:24576
    v_mfma_f32_16x16x32_bf16 v[180:183], a[44:47], v[164:167], v[180:183]
    ds_read_b128 a[100:103], v15 offset:26624
    s_waitcnt vmcnt(16) lgkmcnt(14)
    s_barrier
    s_add_u32 m0, s93, 81920
    v_mfma_f32_16x16x32_bf16 v[128:131], v[144:147], a[48:51], v[128:131]
    ds_read_b64_tr_b16 v[160:161], v36 offset:40960
    ds_read_b64_tr_b16 v[162:163], v36 offset:41472
    buffer_load_dwordx4 v8, s[12:15], s81 offen offset:0 lds
    v_mfma_f32_16x16x32_bf16 v[168:171], a[48:51], v[148:151], v[168:171]
    ds_read_b64_tr_b16 v[164:165], v36 offset:41984
    ds_read_b64_tr_b16 v[166:167], v36 offset:42496
    v_mfma_f32_16x16x32_bf16 v[132:135], v[144:147], a[52:55], v[132:135]
    ds_read_b128 a[104:107], v15 offset:28672
    buffer_load_dwordx4 v8, s[12:15], s81 offen offset:1024 lds
    v_mfma_f32_16x16x32_bf16 v[172:175], a[52:55], v[148:151], v[172:175]
    ds_read_b128 a[108:111], v15 offset:30720
    v_mfma_f32_16x16x32_bf16 v[136:139], v[144:147], a[56:59], v[136:139]
    ds_read_b128 a[112:115], v16 offset:24576
    s_add_u32 m0, s93, 90112
    v_mfma_f32_16x16x32_bf16 v[176:179], a[56:59], v[148:151], v[176:179]
    ds_read_b128 a[116:119], v16 offset:26624
    buffer_load_dwordx4 v0, s[12:15], s81 offen offset:0 lds
    v_mfma_f32_16x16x32_bf16 v[140:143], v[144:147], a[60:63], v[140:143]
    ds_read_b128 a[120:123], v16 offset:28672
    v_mfma_f32_16x16x32_bf16 v[180:183], a[60:63], v[148:151], v[180:183]
    ds_read_b128 a[124:127], v16 offset:30720
    s_waitcnt vmcnt(15) lgkmcnt(12)
    s_barrier
    v_mfma_f32_16x16x32_bf16 v[128:131], v[152:155], a[64:67], v[128:131]
    ds_read_b64_tr_b16 v[144:145], v36 offset:49152
    ds_read_b64_tr_b16 v[146:147], v36 offset:49664
    buffer_load_dwordx4 v0, s[12:15], s81 offen offset:1024 lds
    v_mfma_f32_16x16x32_bf16 v[168:171], a[64:67], v[156:159], v[168:171]
    ds_read_b64_tr_b16 v[148:149], v36 offset:50176
    ds_read_b64_tr_b16 v[150:151], v36 offset:50688
    s_add_u32 m0, s93, 98304
    v_mfma_f32_16x16x32_bf16 v[132:135], v[152:155], a[68:71], v[132:135]
    ds_read_b128 a[128:131], v15 offset:32768
    buffer_load_dwordx4 v8, s[12:15], s82 offen offset:0 lds
    v_mfma_f32_16x16x32_bf16 v[172:175], a[68:71], v[156:159], v[172:175]
    ds_read_b128 a[132:135], v15 offset:34816
    v_mfma_f32_16x16x32_bf16 v[136:139], v[152:155], a[72:75], v[136:139]
    ds_read_b128 a[136:139], v15 offset:36864
    v_mfma_f32_16x16x32_bf16 v[176:179], a[72:75], v[156:159], v[176:179]
    ds_read_b128 a[140:143], v15 offset:38912
    buffer_load_dwordx4 v8, s[12:15], s82 offen offset:1024 lds
    v_mfma_f32_16x16x32_bf16 v[140:143], v[152:155], a[76:79], v[140:143]
    ds_read_b128 a[144:147], v16 offset:32768
    v_mfma_f32_16x16x32_bf16 v[180:183], a[76:79], v[156:159], v[180:183]
    ds_read_b128 a[148:151], v16 offset:34816
    s_waitcnt vmcnt(14) lgkmcnt(10)
    s_barrier
    s_add_u32 m0, s93, 106496
    v_mfma_f32_16x16x32_bf16 v[128:131], v[160:163], a[80:83], v[128:131]
    ds_read_b64_tr_b16 v[152:153], v36 offset:57344
    ds_read_b64_tr_b16 v[154:155], v36 offset:57856
    buffer_load_dwordx4 v0, s[12:15], s82 offen offset:0 lds
    v_mfma_f32_16x16x32_bf16 v[168:171], a[80:83], v[164:167], v[168:171]
    ds_read_b64_tr_b16 v[156:157], v36 offset:58368
    ds_read_b64_tr_b16 v[158:159], v36 offset:58880
    v_mfma_f32_16x16x32_bf16 v[132:135], v[160:163], a[84:87], v[132:135]
    ds_read_b128 a[152:155], v16 offset:36864
    buffer_load_dwordx4 v0, s[12:15], s82 offen offset:1024 lds
    v_mfma_f32_16x16x32_bf16 v[172:175], a[84:87], v[164:167], v[172:175]
    ds_read_b128 a[156:159], v16 offset:38912
    s_add_u32 m0, s93, 0
    v_mfma_f32_16x16x32_bf16 v[136:139], v[160:163], a[88:91], v[136:139]
    ds_read_b128 a[160:163], v15 offset:40960
    buffer_load_dwordx4 v8, s[12:15], s83 offen offset:0 lds
    v_mfma_f32_16x16x32_bf16 v[176:179], a[88:91], v[164:167], v[176:179]
    ds_read_b128 a[164:167], v15 offset:43008
    v_mfma_f32_16x16x32_bf16 v[140:143], v[160:163], a[92:95], v[140:143]
    ds_read_b128 a[168:171], v15 offset:45056
    buffer_load_dwordx4 v8, s[12:15], s83 offen offset:1024 lds
    v_mfma_f32_16x16x32_bf16 v[180:183], a[92:95], v[164:167], v[180:183]
    ds_read_b128 a[172:175], v15 offset:47104
    s_waitcnt vmcnt(14) lgkmcnt(15)
    s_barrier
    s_add_u32 m0, s93, 114688
    v_mfma_f32_16x16x32_bf16 v[128:131], v[144:147], a[96:99], v[128:131]
    ds_read_b64_tr_b16 v[160:161], v36 offset:0
    ds_read_b64_tr_b16 v[162:163], v36 offset:512
    buffer_load_dwordx4 v0, s[12:15], s83 offen offset:0 lds
    v_mfma_f32_16x16x32_bf16 v[168:171], a[96:99], v[148:151], v[168:171]
    ds_read_b64_tr_b16 v[164:165], v36 offset:1024
    ds_read_b64_tr_b16 v[166:167], v36 offset:1536
    v_mfma_f32_16x16x32_bf16 v[132:135], v[144:147], a[100:103], v[132:135]
    ds_read_b128 a[176:179], v16 offset:40960
    buffer_load_dwordx4 v0, s[12:15], s83 offen offset:1024 lds
    v_mfma_f32_16x16x32_bf16 v[172:175], a[100:103], v[148:151], v[172:175]
    ds_read_b128 a[180:183], v16 offset:43008
    v_mfma_f32_16x16x32_bf16 v[136:139], v[144:147], a[104:107], v[136:139]
    ds_read_b128 a[184:187], v16 offset:45056
    v_mfma_f32_16x16x32_bf16 v[176:179], a[104:107], v[148:151], v[176:179]
    ds_read_b128 a[188:191], v16 offset:47104
    buffer_load_dwordx2 v[34:35], off, s[24:27], 0 sc1
    v_mfma_f32_16x16x32_bf16 v[140:143], v[144:147], a[108:111], v[140:143]
    ds_read_b128 a[192:195], v15 offset:49152
    v_mfma_f32_16x16x32_bf16 v[180:183], a[108:111], v[148:151], v[180:183]
    ds_read_b128 a[196:199], v15 offset:51200
    s_waitcnt vmcnt(13) lgkmcnt(14)
    s_barrier
    s_add_u32 m0, s92, 8192
    v_mfma_f32_16x16x32_bf16 v[128:131], v[152:155], a[112:115], v[128:131]
    ds_read_b64_tr_b16 v[144:145], v36 offset:8192
    ds_read_b64_tr_b16 v[146:147], v36 offset:8704
    buffer_load_dwordx4 v8, s[16:19], s76 offen offset:0 lds
    v_mfma_f32_16x16x32_bf16 v[168:171], a[112:115], v[156:159], v[168:171]
    ds_read_b64_tr_b16 v[148:149], v36 offset:9216
    ds_read_b64_tr_b16 v[150:151], v36 offset:9728
    s_add_u32 m0, s92, 12288
    v_mfma_f32_16x16x32_bf16 v[132:135], v[152:155], a[116:119], v[132:135]
    ds_read_b128 a[200:203], v15 offset:53248
    buffer_load_dwordx4 v0, s[16:19], s76 offen offset:0 lds
    v_mfma_f32_16x16x32_bf16 v[172:175], a[116:119], v[156:159], v[172:175]
    ds_read_b128 a[204:207], v15 offset:55296
    v_mfma_f32_16x16x32_bf16 v[136:139], v[152:155], a[120:123], v[136:139]
    ds_read_b128 a[208:211], v16 offset:49152
    s_add_u32 m0, s92, 16384
    v_mfma_f32_16x16x32_bf16 v[176:179], a[120:123], v[156:159], v[176:179]
    ds_read_b128 a[212:215], v16 offset:51200
    buffer_load_dwordx4 v8, s[16:19], s77 offen offset:0 lds
    v_mfma_f32_16x16x32_bf16 v[140:143], v[152:155], a[124:127], v[140:143]
    ds_read_b128 a[216:219], v16 offset:53248
    v_mfma_f32_16x16x32_bf16 v[180:183], a[124:127], v[156:159], v[180:183]
    ds_read_b128 a[220:223], v16 offset:55296
    s_waitcnt vmcnt(14) lgkmcnt(12)
    s_barrier
    s_add_u32 m0, s92, 20480
    v_mfma_f32_16x16x32_bf16 v[128:131], v[160:163], a[128:131], v[128:131]
    ds_read_b64_tr_b16 v[152:153], v36 offset:16384
    ds_read_b64_tr_b16 v[154:155], v36 offset:16896
    buffer_load_dwordx4 v0, s[16:19], s77 offen offset:0 lds
    v_mfma_f32_16x16x32_bf16 v[168:171], a[128:131], v[164:167], v[168:171]
    ds_read_b64_tr_b16 v[156:157], v36 offset:17408
    ds_read_b64_tr_b16 v[158:159], v36 offset:17920
    v_mfma_f32_16x16x32_bf16 v[132:135], v[160:163], a[132:135], v[132:135]
    ds_read_b128 a[224:227], v15 offset:57344
    v_mfma_f32_16x16x32_bf16 v[172:175], a[132:135], v[164:167], v[172:175]
    ds_read_b128 a[228:231], v15 offset:59392
    s_add_u32 m0, s92, 24576
    v_mfma_f32_16x16x32_bf16 v[136:139], v[160:163], a[136:139], v[136:139]
    ds_read_b128 a[232:235], v15 offset:61440
    buffer_load_dwordx4 v8, s[16:19], s78 offen offset:0 lds
    v_mfma_f32_16x16x32_bf16 v[176:179], a[136:139], v[164:167], v[176:179]
    ds_read_b128 a[236:239], v15 offset:63488
    v_mfma_f32_16x16x32_bf16 v[140:143], v[160:163], a[140:143], v[140:143]
    ds_read_b128 a[240:243], v16 offset:57344
    v_mfma_f32_16x16x32_bf16 v[180:183], a[140:143], v[164:167], v[180:183]
    ds_read_b128 a[244:247], v16 offset:59392
    s_waitcnt vmcnt(14) lgkmcnt(10)
    s_barrier
    s_add_u32 m0, s92, 28672
    v_mfma_f32_16x16x32_bf16 v[128:131], v[144:147], a[144:147], v[128:131]
    ds_read_b64_tr_b16 v[160:161], v36 offset:24576
    buffer_load_dwordx4 v0, s[16:19], s78 offen offset:0 lds
    v_mfma_f32_16x16x32_bf16 v[168:171], a[144:147], v[148:151], v[168:171]
    ds_read_b64_tr_b16 v[162:163], v36 offset:25088
    v_mfma_f32_16x16x32_bf16 v[132:135], v[144:147], a[148:151], v[132:135]
    ds_read_b64_tr_b16 v[164:165], v36 offset:25600
    v_mfma_f32_16x16x32_bf16 v[172:175], a[148:151], v[148:151], v[172:175]
    ds_read_b64_tr_b16 v[166:167], v36 offset:26112
    s_add_u32 m0, s92, 32768
    v_mfma_f32_16x16x32_bf16 v[136:139], v[144:147], a[152:155], v[136:139]
    ds_read_b128 a[248:251], v16 offset:61440
    buffer_load_dwordx4 v8, s[16:19], s79 offen offset:0 lds
    v_mfma_f32_16x16x32_bf16 v[176:179], a[152:155], v[148:151], v[176:179]
    ds_read_b128 a[252:255], v16 offset:63488
    v_mfma_f32_16x16x32_bf16 v[140:143], v[144:147], a[156:159], v[140:143]
    v_mfma_f32_16x16x32_bf16 v[180:183], a[156:159], v[148:151], v[180:183]
    s_waitcnt vmcnt(14) lgkmcnt(12)
    s_barrier
    s_add_u32 m0, s92, 36864
    v_mfma_f32_16x16x32_bf16 v[128:131], v[152:155], a[160:163], v[128:131]
    ds_read_b64_tr_b16 v[144:145], v36 offset:32768
    buffer_load_dwordx4 v0, s[16:19], s79 offen offset:0 lds
    v_mfma_f32_16x16x32_bf16 v[168:171], a[160:163], v[156:159], v[168:171]
    ds_read_b64_tr_b16 v[146:147], v36 offset:33280
    s_add_u32 m0, s92, 40960
    v_mfma_f32_16x16x32_bf16 v[132:135], v[152:155], a[164:167], v[132:135]
    ds_read_b64_tr_b16 v[148:149], v36 offset:33792
    buffer_load_dwordx4 v8, s[16:19], s80 offen offset:0 lds
    v_mfma_f32_16x16x32_bf16 v[172:175], a[164:167], v[156:159], v[172:175]
    ds_read_b64_tr_b16 v[150:151], v36 offset:34304
    v_mfma_f32_16x16x32_bf16 v[136:139], v[152:155], a[168:171], v[136:139]
    s_add_u32 m0, s92, 45056
    v_mfma_f32_16x16x32_bf16 v[176:179], a[168:171], v[156:159], v[176:179]
    buffer_load_dwordx4 v0, s[16:19], s80 offen offset:0 lds
    v_mfma_f32_16x16x32_bf16 v[140:143], v[152:155], a[172:175], v[140:143]
    v_mfma_f32_16x16x32_bf16 v[180:183], a[172:175], v[156:159], v[180:183]
    s_waitcnt vmcnt(15) lgkmcnt(4)
    s_barrier
    s_add_u32 m0, s92, 49152
    v_mfma_f32_16x16x32_bf16 v[128:131], v[160:163], a[176:179], v[128:131]
    ds_read_b64_tr_b16 v[152:153], v36 offset:40960
    buffer_load_dwordx4 v8, s[16:19], s81 offen offset:0 lds
    v_mfma_f32_16x16x32_bf16 v[168:171], a[176:179], v[164:167], v[168:171]
    ds_read_b64_tr_b16 v[154:155], v36 offset:41472
    s_add_u32 m0, s92, 53248
    v_mfma_f32_16x16x32_bf16 v[132:135], v[160:163], a[180:183], v[132:135]
    ds_read_b64_tr_b16 v[156:157], v36 offset:41984
    buffer_load_dwordx4 v0, s[16:19], s81 offen offset:0 lds
    v_mfma_f32_16x16x32_bf16 v[172:175], a[180:183], v[164:167], v[172:175]
    ds_read_b64_tr_b16 v[158:159], v36 offset:42496
    v_mfma_f32_16x16x32_bf16 v[136:139], v[160:163], a[184:187], v[136:139]
    s_add_u32 m0, s92, 57344
    v_mfma_f32_16x16x32_bf16 v[176:179], a[184:187], v[164:167], v[176:179]
    buffer_load_dwordx4 v8, s[16:19], s82 offen offset:0 lds
    v_mfma_f32_16x16x32_bf16 v[140:143], v[160:163], a[188:191], v[140:143]
    v_mfma_f32_16x16x32_bf16 v[180:183], a[188:191], v[164:167], v[180:183]
    s_waitcnt vmcnt(16) lgkmcnt(4)
    s_barrier
    s_add_u32 m0, s92, 61440
    v_mfma_f32_16x16x32_bf16 v[128:131], v[144:147], a[192:195], v[128:131]
    ds_read_b64_tr_b16 v[160:161], v12 offset:0
    buffer_load_dwordx4 v0, s[16:19], s82 offen offset:0 lds
    v_mfma_f32_16x16x32_bf16 v[168:171], a[192:195], v[148:151], v[168:171]
    ds_read_b64_tr_b16 v[162:163], v12 offset:512
    s_add_u32 m0, s92, 65536
    v_mfma_f32_16x16x32_bf16 v[132:135], v[144:147], a[196:199], v[132:135]
    ds_read_b64_tr_b16 v[164:165], v12 offset:1024
    buffer_load_dwordx4 v8, s[16:19], s83 offen offset:0 lds
    v_mfma_f32_16x16x32_bf16 v[172:175], a[196:199], v[148:151], v[172:175]
    ds_read_b64_tr_b16 v[166:167], v12 offset:1536
    v_mfma_f32_16x16x32_bf16 v[136:139], v[144:147], a[200:203], v[136:139]
    s_add_u32 m0, s92, 69632
    v_mfma_f32_16x16x32_bf16 v[176:179], a[200:203], v[148:151], v[176:179]
    buffer_load_dwordx4 v0, s[16:19], s83 offen offset:0 lds
    v_mfma_f32_16x16x32_bf16 v[140:143], v[144:147], a[204:207], v[140:143]
    v_mfma_f32_16x16x32_bf16 v[180:183], a[204:207], v[148:151], v[180:183]
    s_waitcnt vmcnt(17) lgkmcnt(4)
    s_barrier
    s_add_u32 m0, s95, 131072
    v_mfma_f32_16x16x32_bf16 v[128:131], v[152:155], a[208:211], v[128:131]
    ds_read_b64_tr_b16 v[144:145], v36 offset:49152
    buffer_load_dwordx4 v9, s[8:11], s74 offen lds
    v_mfma_f32_16x16x32_bf16 v[168:171], a[208:211], v[156:159], v[168:171]
    ds_read_b64_tr_b16 v[146:147], v36 offset:49664
    v_mfma_f32_16x16x32_bf16 v[132:135], v[152:155], a[212:215], v[132:135]
    ds_read_b64_tr_b16 v[148:149], v36 offset:50176
    buffer_load_dwordx4 v10, s[8:11], s74 offen offset:1024 lds
    v_mfma_f32_16x16x32_bf16 v[172:175], a[212:215], v[156:159], v[172:175]
    ds_read_b64_tr_b16 v[150:151], v36 offset:50688
    v_mfma_f32_16x16x32_bf16 v[136:139], v[152:155], a[216:219], v[136:139]
    s_add_u32 m0, s95, 133120
    v_mfma_f32_16x16x32_bf16 v[176:179], a[216:219], v[156:159], v[176:179]
    buffer_load_dwordx4 v9, s[8:11], s70 offen lds
    v_mfma_f32_16x16x32_bf16 v[140:143], v[152:155], a[220:223], v[140:143]
    v_mfma_f32_16x16x32_bf16 v[180:183], a[220:223], v[156:159], v[180:183]
    s_waitcnt lgkmcnt(4)
    s_barrier
    v_mfma_f32_16x16x32_bf16 v[128:131], v[160:163], a[224:227], v[128:131]
    buffer_load_dwordx4 v10, s[8:11], s70 offen offset:1024 lds
    v_mfma_f32_16x16x32_bf16 v[168:171], a[224:227], v[164:167], v[168:171]
    v_mfma_f32_16x16x32_bf16 v[132:135], v[160:163], a[228:231], v[132:135]
    v_mfma_f32_16x16x32_bf16 v[172:175], a[228:231], v[164:167], v[172:175]
    s_add_u32 m0, s94, 73728
    v_mfma_f32_16x16x32_bf16 v[136:139], v[160:163], a[232:235], v[136:139]
    buffer_load_dwordx4 v8, s[28:31], s76 offen offset:0 lds
    v_mfma_f32_16x16x32_bf16 v[176:179], a[232:235], v[164:167], v[176:179]
    v_mfma_f32_16x16x32_bf16 v[140:143], v[160:163], a[236:239], v[140:143]
    v_mfma_f32_16x16x32_bf16 v[180:183], a[236:239], v[164:167], v[180:183]
    s_waitcnt lgkmcnt(0)
    s_barrier
    v_mfma_f32_16x16x32_bf16 v[128:131], v[144:147], a[240:243], v[128:131]
    buffer_load_dwordx4 v8, s[28:31], s76 offen offset:1024 lds
    v_mfma_f32_16x16x32_bf16 v[168:171], a[240:243], v[148:151], v[168:171]
    v_mfma_f32_16x16x32_bf16 v[132:135], v[144:147], a[244:247], v[132:135]
    v_mfma_f32_16x16x32_bf16 v[172:175], a[244:247], v[148:151], v[172:175]
    v_mfma_f32_16x16x32_bf16 v[136:139], v[144:147], a[248:251], v[136:139]
    buffer_load_dwordx4 v8, s[28:31], s76 offen offset:2048 lds
    v_mfma_f32_16x16x32_bf16 v[176:179], a[248:251], v[148:151], v[176:179]
    v_mfma_f32_16x16x32_bf16 v[140:143], v[144:147], a[252:255], v[140:143]
    v_mfma_f32_16x16x32_bf16 v[180:183], a[252:255], v[148:151], v[180:183]
    s_mov_b64 exec, s[60:61]
    ds_read_b128 v[200:203], v19 offset:0
    ds_read_b128 v[204:207], v19 offset:64
    ds_read_b128 v[208:211], v19 offset:128
    ds_read_b128 v[212:215], v19 offset:192
    s_mov_b64 exec, -1
    s_add_u32 m0, s94, 86016
    s_nop 0
    buffer_load_dwordx4 v0, s[28:31], s76 offen offset:0 lds
    buffer_load_dwordx4 v0, s[28:31], s76 offen offset:1024 lds
    buffer_load_dwordx4 v0, s[28:31], s76 offen offset:2048 lds
    v_cvt_pk_bf16_f32 v96, v128, v129
    v_cvt_pk_bf16_f32 v97, v130, v131
    v_cvt_pk_bf16_f32 v98, v132, v133
    v_cvt_pk_bf16_f32 v99, v134, v135
    v_cvt_pk_bf16_f32 v100, v136, v137
    v_cvt_pk_bf16_f32 v101, v138, v139
    v_cvt_pk_bf16_f32 v102, v140, v141
    v_cvt_pk_bf16_f32 v103, v142, v143
    s_waitcnt vmcnt(24)
    s_barrier
    ds_read_b64_tr_b16 v[152:153], v13 offset:8192
    ds_read_b64_tr_b16 v[154:155], v13 offset:8704
    ds_read_b64_tr_b16 v[160:161], v13 offset:12288
    ds_read_b64_tr_b16 v[162:163], v13 offset:12800
    s_waitcnt lgkmcnt(4)
    s_cmp_ge_u32 s67, 2
    s_cbranch_scc1 L_gh
    s_cmp_eq_u32 s67, 1
    s_cbranch_scc1 L_g1
L_g0:
    v_mfma_f32_16x16x32_bf16 v[184:187], v[200:203], a[0:3], 0
    v_mfma_f32_16x16x32_bf16 v[188:191], v[200:203], a[4:7], 0
    v_mfma_f32_16x16x32_bf16 v[192:195], v[200:203], a[8:11], 0
    v_mfma_f32_16x16x32_bf16 v[196:199], v[200:203], a[12:15], 0
    v_mfma_f32_16x16x32_bf16 v[184:187], v[204:207], a[16:19], v[184:187]
    v_mfma_f32_16x16x32_bf16 v[188:191], v[204:207], a[20:23], v[188:191]
    v_mfma_f32_16x16x32_bf16 v[192:195], v[204:207], a[24:27], v[192:195]
    v_mfma_f32_16x16x32_bf16 v[196:199], v[204:207], a[28:31], v[196:199]
    v_mfma_f32_16x16x32_bf16 v[184:187], v[208:211], a[32:35], v[184:187]
    v_mfma_f32_16x16x32_bf16 v[188:191], v[208:211], a[36:39], v[188:191]
    v_mfma_f32_16x16x32_bf16 v[192:195], v[208:211], a[40:43], v[192:195]
    v_mfma_f32_16x16x32_bf16 v[196:199], v[208:211], a[44:47], v[196:199]
    v_mfma_f32_16x16x32_bf16 v[184:187], v[212:215], a[48:51], v[184:187]
    v_mfma_f32_16x16x32_bf16 v[188:191], v[212:215], a[52:55], v[188:191]
    v_mfma_f32_16x16x32_bf16 v[192:195], v[212:215], a[56:59], v[192:195]
    v_mfma_f32_16x16x32_bf16 v[196:199], v[212:215], a[60:63], v[196:199]
    s_branch L_ge
L_g1:
    v_mfma_f32_16x16x32_bf16 v[184:187], v[200:203], a[64:67], 0
    v_mfma_f32_16x16x32_bf16 v[188:191], v[200:203], a[68:71], 0
    v_mfma_f32_16x16x32_bf16 v[192:195], v[200:203], a[72:75], 0
    v_mfma_f32_16x16x32_bf16 v[196:199], v[200:203], a[76:79], 0
    v_mfma_f32_16x16x32_bf16 v[184:187], v[204:207], a[80:83], v[184:187]
    v_mfma_f32_16x16x32_bf16 v[188:191], v[204:207], a[84:87], v[188:191]
    v_mfma_f32_16x16x32_bf16 v[192:195], v[204:207], a[88:91], v[192:195]
    v_mfma_f32_16x16x32_bf16 v[196:199], v[204:207], a[92:95], v[196:199]
    v_mfma_f32_16x16x32_bf16 v[184:187], v[208:211], a[96:99], v[184:187]
    v_mfma_f32_16x16x32_bf16 v[188:191], v[208:211], a[100:103], v[188:191]
    v_mfma_f32_16x16x32_bf16 v[192:195], v[208:211], a[104:107], v[192:195]
    v_mfma_f32_16x16x32_bf16 v[196:199], v[208:211], a[108:111], v[196:199]
    v_mfma_f32_16x16x32_bf16 v[184:187], v[212:215], a[112:115], v[184:187]
    v_mfma_f32_16x16x32_bf16 v[188:191], v[212:215], a[116:119], v[188:191]
    v_mfma_f32_16x16x32_bf16 v[192:195], v[212:215], a[120:123], v[192:195]
    v_mfma_f32_16x16x32_bf16 v[196:199], v[212:215], a[124:127], v[196:199]
    s_branch L_ge
L_gh:
    s_cmp_eq_u32 s67, 3
    s_cbranch_scc1 L_g3
L_g2:
    v_mfma_f32_16x16x32_bf16 v[184:187], v[200:203], a[128:131], 0
    v_mfma_f32_16x16x32_bf16 v[188:191], v[200:203], a[132:135], 0
    v_mfma_f32_16x16x32_bf16 v[192:195], v[200:203], a[136:139], 0
    v_mfma_f32_16x16x32_bf16 v[196:199], v[200:203], a[140:143], 0
    v_mfma_f32_16x16x32_bf16 v[184:187], v[204:207], a[144:147], v[184:187]
    v_mfma_f32_16x16x32_bf16 v[188:191], v[204:207], a[148:151], v[188:191]
    v_mfma_f32_16x16x32_bf16 v[192:195], v[204:207], a[152:155], v[192:195]
    v_mfma_f32_16x16x32_bf16 v[196:199], v[204:207], a[156:159], v[196:199]
    v_mfma_f32_16x16x32_bf16 v[184:187], v[208:211], a[160:163], v[184:187]
    v_mfma_f32_16x16x32_bf16 v[188:191], v[208:211], a[164:167], v[188:191]
    v_mfma_f32_16x16x32_bf16 v[192:195], v[208:211], a[168:171], v[192:195]
    v_mfma_f32_16x16x32_bf16 v[196:199], v[208:211], a[172:175], v[196:199]
    v_mfma_f32_16x16x32_bf16 v[184:187], v[212:215], a[176:179], v[184:187]
    v_mfma_f32_16x16x32_bf16 v[188:191], v[212:215], a[180:183], v[188:191]
    v_mfma_f32_16x16x32_bf16 v[192:195], v[212:215], a[184:187], v[192:195]
    v_mfma_f32_16x16x32_bf16 v[196:199], v[212:215], a[188:191], v[196:199]
    s_branch L_ge
L_g3:
    v_mfma_f32_16x16x32_bf16 v[184:187], v[200:203], a[192:195], 0
    v_mfma_f32_16x16x32_bf16 v[188:191], v[200:203], a[196:199], 0
    v_mfma_f32_16x16x32_bf16 v[192:195], v[200:203], a[200:203], 0
    v_mfma_f32_16x16x32_bf16 v[196:199], v[200:203], a[204:207], 0
    v_mfma_f32_16x16x32_bf16 v[184:187], v[204:207], a[208:211], v[184:187]
    v_mfma_f32_16x16x32_bf16 v[188:191], v[204:207], a[212:215], v[188:191]
    v_mfma_f32_16x16x32_bf16 v[192:195], v[204:207], a[216:219], v[192:195]
    v_mfma_f32_16x16x32_bf16 v[196:199], v[204:207], a[220:223], v[196:199]
    v_mfma_f32_16x16x32_bf16 v[184:187], v[208:211], a[224:227], v[184:187]
    v_mfma_f32_16x16x32_bf16 v[188:191], v[208:211], a[228:231], v[188:191]
    v_mfma_f32_16x16x32_bf16 v[192:195], v[208:211], a[232:235], v[192:195]
    v_mfma_f32_16x16x32_bf16 v[196:199], v[208:211], a[236:239], v[196:199]
    v_mfma_f32_16x16x32_bf16 v[184:187], v[212:215], a[240:243], v[184:187]
    v_mfma_f32_16x16x32_bf16 v[188:191], v[212:215], a[244:247], v[188:191]
    v_mfma_f32_16x16x32_bf16 v[192:195], v[212:215], a[248:251], v[192:195]
    v_mfma_f32_16x16x32_bf16 v[196:199], v[212:215], a[252:255], v[196:199]
L_ge:
    s_waitcnt vmcnt(20)
    s_barrier
    s_waitcnt lgkmcnt(2)
    v_mfma_f32_16x16x32_bf16 v[128:131], v[152:155], a[0:3], 0
    ds_read_b64_tr_b16 v[144:145], v13 offset:16384
    v_cvt_pk_bf16_f32 v104, v168, v169
    v_cvt_pk_bf16_f32 v105, v170, v171
    v_mfma_f32_16x16x32_bf16 v[132:135], v[152:155], a[4:7], 0
    ds_read_b64_tr_b16 v[146:147], v13 offset:16896
    v_cvt_pk_bf16_f32 v108, v172, v173
    v_cvt_pk_bf16_f32 v109, v174, v175
    v_mfma_f32_16x16x32_bf16 v[136:139], v[152:155], a[8:11], 0
    v_cvt_pk_bf16_f32 v112, v176, v177
    v_cvt_pk_bf16_f32 v113, v178, v179
    v_mfma_f32_16x16x32_bf16 v[140:143], v[152:155], a[12:15], 0
    s_waitcnt lgkmcnt(2)
    v_mfma_f32_16x16x32_bf16 v[128:131], v[160:163], a[16:19], v[128:131]
    ds_read_b64_tr_b16 v[152:153], v13 offset:20480
    v_cvt_pk_bf16_f32 v116, v180, v181
    v_cvt_pk_bf16_f32 v117, v182, v183
    v_mfma_f32_16x16x32_bf16 v[132:135], v[160:163], a[20:23], v[132:135]
    ds_read_b64_tr_b16 v[154:155], v13 offset:20992
    v_permlane16_swap_b32 v96, v98
    v_mfma_f32_16x16x32_bf16 v[136:139], v[160:163], a[24:27], v[136:139]
    v_permlane16_swap_b32 v97, v99
    v_mfma_f32_16x16x32_bf16 v[140:143], v[160:163], a[28:31], v[140:143]
    s_waitcnt lgkmcnt(2)
    v_mfma_f32_16x16x32_bf16 v[128:131], v[144:147], a[32:35], v[128:131]
    ds_read_b64_tr_b16 v[160:161], v13 offset:24576
    v_permlane16_swap_b32 v100, v102
    v_mfma_f32_16x16x32_bf16 v[132:135], v[144:147], a[36:39], v[132:135]
    ds_read_b64_tr_b16 v[162:163], v13 offset:25088
    v_permlane16_swap_b32 v101, v103
    v_mfma_f32_16x16x32_bf16 v[136:139], v[144:147], a[40:43], v[136:139]
    v_permlane16_swap_b32 v104, v106
    v_mfma_f32_16x16x32_bf16 v[140:143], v[144:147], a[44:47], v[140:143]
    s_waitcnt lgkmcnt(2)
    v_mfma_f32_16x16x32_bf16 v[128:131], v[152:155], a[48:51], v[128:131]
    ds_read_b64_tr_b16 v[144:145], v13 offset:28672
    v_permlane16_swap_b32 v105, v107
    v_mfma_f32_16x16x32_bf16 v[132:135], v[152:155], a[52:55], v[132:135]
    ds_read_b64_tr_b16 v[146:147], v13 offset:29184
    v_permlane16_swap_b32 v108, v110
    v_mfma_f32_16x16x32_bf16 v[136:139], v[152:155], a[56:59], v[136:139]
    v_permlane16_swap_b32 v109, v111
    v_mfma_f32_16x16x32_bf16 v[140:143], v[152:155], a[60:63], v[140:143]
    s_waitcnt vmcnt(16) lgkmcnt(2)
    s_barrier
    v_mfma_f32_16x16x32_bf16 v[128:131], v[160:163], a[64:67], v[128:131]
    ds_read_b64_tr_b16 v[152:153], v13 offset:32768
    v_permlane16_swap_b32 v112, v114
    v_mfma_f32_16x16x32_bf16 v[132:135], v[160:163], a[68:71], v[132:135]
    ds_read_b64_tr_b16 v[154:155], v13 offset:33280
    v_permlane16_swap_b32 v113, v115
    v_mfma_f32_16x16x32_bf16 v[136:139], v[160:163], a[72:75], v[136:139]
    v_permlane16_swap_b32 v116, v118
    v_mfma_f32_16x16x32_bf16 v[140:143], v[160:163], a[76:79], v[140:143]
    s_waitcnt lgkmcnt(2)
    v_mfma_f32_16x16x32_bf16 v[128:131], v[144:147], a[80:83], v[128:131]
    ds_read_b64_tr_b16 v[160:161], v13 offset:36864
    v_permlane16_swap_b32 v117, v119
    v_mfma_f32_16x16x32_bf16 v[132:135], v[144:147], a[84:87], v[132:135]
    ds_read_b64_tr_b16 v[162:163], v13 offset:37376
    v_permlane32_swap_b32 v104, v106
    v_mfma_f32_16x16x32_bf16 v[136:139], v[144:147], a[88:91], v[136:139]
    v_permlane32_swap_b32 v105, v107
    v_mfma_f32_16x16x32_bf16 v[140:143], v[144:147], a[92:95], v[140:143]
    s_waitcnt lgkmcnt(2)
    v_mfma_f32_16x16x32_bf16 v[128:131], v[152:155], a[96:99], v[128:131]
    ds_read_b64_tr_b16 v[144:145], v13 offset:40960
    v_permlane32_swap_b32 v108, v110
    v_mfma_f32_16x16x32_bf16 v[132:135], v[152:155], a[100:103], v[132:135]
    ds_read_b64_tr_b16 v[146:147], v13 offset:41472
    v_permlane32_swap_b32 v109, v111
    v_mfma_f32_16x16x32_bf16 v[136:139], v[152:155], a[104:107], v[136:139]
    v_permlane32_swap_b32 v112, v114
    v_mfma_f32_16x16x32_bf16 v[140:143], v[152:155], a[108:111], v[140:143]
    s_sub_u32 s84, s96, 540672
    s_cmp_ge_u32 s66, 4
    s_cselect_b32 s84, s84, 2147418112
    s_cselect_b32 s88, -1, 0
    s_waitcnt lgkmcnt(2)
    v_mfma_f32_16x16x32_bf16 v[128:131], v[160:163], a[112:115], v[128:131]
    ds_read_b64_tr_b16 v[152:153], v13 offset:45056
    v_permlane32_swap_b32 v113, v115
    v_mfma_f32_16x16x32_bf16 v[132:135], v[160:163], a[116:119], v[132:135]
    ds_read_b64_tr_b16 v[154:155], v13 offset:45568
    v_permlane32_swap_b32 v116, v118
    v_mfma_f32_16x16x32_bf16 v[136:139], v[160:163], a[120:123], v[136:139]
    v_permlane32_swap_b32 v117, v119
    v_mfma_f32_16x16x32_bf16 v[140:143], v[160:163], a[124:127], v[140:143]
    s_sub_u32 s85, s96, 405504
    s_cmp_ge_u32 s66, 3
    s_cselect_b32 s85, s85, 2147418112
    s_cselect_b32 s89, -1, 0
    s_waitcnt vmcnt(12) lgkmcnt(2)
    s_barrier
    v_mfma_f32_16x16x32_bf16 v[128:131], v[144:147], a[128:131], v[128:131]
    ds_read_b64_tr_b16 v[160:161], v13 offset:49152
    s_sub_u32 s86, s96, 270336
    s_cmp_ge_u32 s66, 2
    s_cselect_b32 s86, s86, 2147418112
    s_cselect_b32 s90, -1, 0
    v_mfma_f32_16x16x32_bf16 v[132:135], v[144:147], a[132:135], v[132:135]
    ds_read_b64_tr_b16 v[162:163], v13 offset:49664
    buffer_store_dwordx4 v[96:99], v20, s[40:43], s96 offen offset:0 sc1
    v_mfma_f32_16x16x32_bf16 v[136:139], v[144:147], a[136:139], v[136:139]
    v_mfma_f32_16x16x32_bf16 v[140:143], v[144:147], a[140:143], v[140:143]
    s_waitcnt lgkmcnt(2)
    v_mfma_f32_16x16x32_bf16 v[128:131], v[152:155], a[144:147], v[128:131]
    ds_read_b64_tr_b16 v[144:145], v13 offset:53248
    v_mfma_f32_16x16x32_bf16 v[132:135], v[152:155], a[148:151], v[132:135]
    ds_read_b64_tr_b16 v[146:147], v13 offset:53760
    buffer_store_dwordx4 v[100:103], v20, s[40:43], s96 offen offset:2048 sc1
    v_mfma_f32_16x16x32_bf16 v[136:139], v[152:155], a[152:155], v[136:139]
    s_mov_b64 exec, s[62:63]
    buffer_store_dwordx4 v[104:107], v21, s[40:43], s96 offen offset:1024 sc1
    buffer_store_dwordx4 v[108:111], v21, s[40:43], s96 offen offset:1536 sc1
    s_mov_b64 exec, -1
    v_mfma_f32_16x16x32_bf16 v[140:143], v[152:155], a[156:159], v[140:143]
    s_waitcnt lgkmcnt(2)
    v_mfma_f32_16x16x32_bf16 v[128:131], v[160:163], a[160:163], v[128:131]
    ds_read_b64_tr_b16 v[152:153], v13 offset:57344
    s_sub_u32 s84, s96, 540672
    s_cmp_ge_u32 s66, 4
    s_cselect_b32 s84, s84, 2147418112
    s_cselect_b32 s88, -1, 0
    v_mfma_f32_16x16x32_bf16 v[132:135], v[160:163], a[164:167], v[132:135]
    ds_read_b64_tr_b16 v[154:155], v13 offset:57856
    s_mov_b64 exec, s[62:63]
    buffer_store_dwordx4 v[112:115], v21, s[40:43], s96 offen offset:3072 sc1
    buffer_store_dwordx4 v[116:119], v21, s[40:43], s96 offen offset:3584 sc1
    s_mov_b64 exec, -1
    v_mfma_f32_16x16x32_bf16 v[136:139], v[160:163], a[168:171], v[136:139]
    v_mfma_f32_16x16x32_bf16 v[140:143], v[160:163], a[172:175], v[140:143]
    s_waitcnt lgkmcnt(2)
    v_mfma_f32_16x16x32_bf16 v[128:131], v[144:147], a[176:179], v[128:131]
    ds_read_b64_tr_b16 v[160:161], v13 offset:61440
    s_add_u32 m0, s94, 98304
    s_sub_u32 s85, s96, 405504
    s_cmp_ge_u32 s66, 3
    s_cselect_b32 s85, s85, 2147418112
    s_cselect_b32 s89, -1, 0
    v_mfma_f32_16x16x32_bf16 v[132:135], v[144:147], a[180:183], v[132:135]
    ds_read_b64_tr_b16 v[162:163], v13 offset:61952
    buffer_load_dwordx4 v8, s[28:31], s77 offen offset:0 lds
    v_mfma_f32_16x16x32_bf16 v[136:139], v[144:147], a[184:187], v[136:139]
    v_mfma_f32_16x16x32_bf16 v[140:143], v[144:147], a[188:191], v[140:143]
    s_waitcnt vmcnt(17) lgkmcnt(2)
    s_barrier
    v_mfma_f32_16x16x32_bf16 v[128:131], v[152:155], a[192:195], v[128:131]
    ds_read_b64_tr_b16 v[144:145], v37 offset:0
    s_sub_u32 s86, s96, 270336
    s_cmp_ge_u32 s66, 2
    s_cselect_b32 s86, s86, 2147418112
    s_cselect_b32 s90, -1, 0
    v_mfma_f32_16x16x32_bf16 v[132:135], v[152:155], a[196:199], v[132:135]
    ds_read_b64_tr_b16 v[146:147], v37 offset:512
    buffer_load_dwordx4 v8, s[28:31], s77 offen offset:1024 lds
    v_mfma_f32_16x16x32_bf16 v[136:139], v[152:155], a[200:203], v[136:139]
    v_mfma_f32_16x16x32_bf16 v[140:143], v[152:155], a[204:207], v[140:143]
    s_waitcnt lgkmcnt(2)
    v_mfma_f32_16x16x32_bf16 v[128:131], v[160:163], a[208:211], v[128:131]
    ds_read_b64_tr_b16 v[152:153], v37 offset:4096
    s_sub_u32 s87, s96, 135168
    s_cmp_ge_u32 s66, 1
    s_cselect_b32 s87, s87, 2147418112
    s_cselect_b32 s91, -1, 0
    v_mfma_f32_16x16x32_bf16 v[132:135], v[160:163], a[212:215], v[132:135]
    ds_read_b64_tr_b16 v[154:155], v37 offset:4608
    buffer_load_dwordx4 v8, s[28:31], s77 offen offset:2048 lds
    s_add_u32 m0, s94, 110592
    v_mfma_f32_16x16x32_bf16 v[136:139], v[160:163], a[216:219], v[136:139]
    buffer_load_dwordx4 v0, s[28:31], s77 offen offset:0 lds
    v_mfma_f32_16x16x32_bf16 v[140:143], v[160:163], a[220:223], v[140:143]
    s_waitcnt lgkmcnt(2)
    v_mfma_f32_16x16x32_bf16 v[128:131], v[144:147], a[224:227], v[128:131]
    v_mfma_f32_16x16x32_bf16 v[132:135], v[144:147], a[228:231], v[132:135]
    buffer_load_dwordx4 v0, s[28:31], s77 offen offset:1024 lds
    v_mfma_f32_16x16x32_bf16 v[136:139], v[144:147], a[232:235], v[136:139]
    v_mfma_f32_16x16x32_bf16 v[140:143], v[144:147], a[236:239], v[140:143]
    s_waitcnt lgkmcnt(0)
    v_mfma_f32_16x16x32_bf16 v[128:131], v[152:155], a[240:243], v[128:131]
    v_mfma_f32_16x16x32_bf16 v[132:135], v[152:155], a[244:247], v[132:135]
    buffer_load_dwordx4 v0, s[28:31], s77 offen offset:2048 lds
    s_add_u32 m0, s94, 0
    v_mfma_f32_16x16x32_bf16 v[136:139], v[152:155], a[248:251], v[136:139]
    buffer_load_dwordx4 v8, s[28:31], s78 offen offset:0 lds
    v_mfma_f32_16x16x32_bf16 v[140:143], v[152:155], a[252:255], v[140:143]
L_non:
    v_readfirstlane_b32 s48, v34
    v_readfirstlane_b32 s49, v35
    s_nop 1
    s_or_b64 s[56:57], s[48:49], 0
    s_cbranch_scc0 L_nonr
L_nonok:
    s_mov_b32 s52, 1052289595
    s_mov_b64 exec, 0xffff
    ds_write_b32 v5, v184 offset:0
    ds_write_b32 v5, v188 offset:256
    ds_write_b32 v5, v192 offset:512
    ds_write_b32 v5, v196 offset:768
    s_mov_b64 exec, -1
    buffer_load_dwordx4 v8, s[28:31], s78 offen offset:1024 lds
    buffer_load_dwordx4 v8, s[28:31], s78 offen offset:2048 lds
    s_waitcnt vmcnt(18) lgkmcnt(0)
    s_barrier
    ds_read_b64_tr_b16 v[228:229], v32 offset:9216
    ds_read_b64_tr_b16 v[230:231], v32 offset:9728
    ds_read_b64_tr_b16 v[232:233], v32 offset:10240
    ds_read_b64_tr_b16 v[234:235], v32 offset:10752
    ds_read_b128 v[236:239], v17 offset:0
    ds_read_b64_tr_b16 v[224:225], v32 offset:8192
    ds_read_b64_tr_b16 v[226:227], v32 offset:8704
    ds_read_b128 v[144:147], v4 offset:0
    ds_read_b128 v[148:151], v4 offset:256
    ds_read_b128 v[152:155], v4 offset:512
    ds_read_b128 v[156:159], v4 offset:768
    s_waitcnt vmcnt(15)
    s_barrier
    s_waitcnt lgkmcnt(9)
    v_mfma_f32_16x16x32_bf16 v[184:187], v[228:231], a[0:3], 0
    ds_read_b64_tr_b16 v[244:245], v32 offset:21504
    s_add_u32 m0, s94, 12288
    v_pk_mul_f32 v[128:129], v[128:129], s[52:53] op_sel_hi:[1,0]
    v_mfma_f32_16x16x32_bf16 v[188:191], v[228:231], a[4:7], 0
    ds_read_b64_tr_b16 v[246:247], v32 offset:22016
    buffer_load_dwordx4 v0, s[28:31], s78 offen offset:0 lds
    v_mfma_f32_16x16x32_bf16 v[192:195], v[228:231], a[8:11], 0
    ds_read_b64_tr_b16 v[248:249], v32 offset:22528
    v_pk_mul_f32 v[130:131], v[130:131], s[52:53] op_sel_hi:[1,0]
    v_mfma_f32_16x16x32_bf16 v[196:199], v[228:231], a[12:15], 0
    ds_read_b64_tr_b16 v[250:251], v32 offset:23040
    v_pk_mul_f32 v[132:133], v[132:133], s[52:53] op_sel_hi:[1,0]
    s_waitcnt lgkmcnt(11)
    v_mfma_f32_16x16x32_bf16 v[204:207], a[0:3], v[232:235], 0
    ds_read_b128 v[252:255], v18 offset:0
    buffer_load_dwordx4 v0, s[28:31], s78 offen offset:1024 lds
    v_mfma_f32_16x16x32_bf16 v[208:211], a[4:7], v[232:235], 0
    ds_read_b64_tr_b16 v[240:241], v32 offset:20480
    v_pk_mul_f32 v[134:135], v[134:135], s[52:53] op_sel_hi:[1,0]
    v_mfma_f32_16x16x32_bf16 v[212:215], a[8:11], v[232:235], 0
    ds_read_b64_tr_b16 v[242:243], v32 offset:20992
    v_pk_mul_f32 v[136:137], v[136:137], s[52:53] op_sel_hi:[1,0]
    v_mfma_f32_16x16x32_bf16 v[216:219], a[12:15], v[232:235], 0
    buffer_load_dwordx4 v0, s[28:31], s78 offen offset:2048 lds
    s_waitcnt lgkmcnt(13)
    v_mfma_f32_16x16x32_bf16 v[200:203], v[228:231], v[236:239], 0
    v_pk_mul_f32 v[138:139], v[138:139], s[52:53] op_sel_hi:[1,0]
    v_mfma_f32_16x16x32_bf16 v[220:223], v[236:239], v[232:235], 0
    s_add_u32 m0, s94, 24576
    v_pk_mul_f32 v[140:141], v[140:141], s[52:53] op_sel_hi:[1,0]
    s_waitcnt lgkmcnt(11)
    v_mfma_f32_16x16x32_bf16 v[168:171], v[224:227], a[0:3], 0
    buffer_load_dwordx4 v8, s[28:31], s79 offen offset:0 lds
    v_mfma_f32_16x16x32_bf16 v[172:175], v[224:227], a[4:7], 0
    v_pk_mul_f32 v[142:143], v[142:143], s[52:53] op_sel_hi:[1,0]
    v_mfma_f32_16x16x32_bf16 v[176:179], v[224:227], a[8:11], 0
    v_cvt_pk_bf16_f32 v120, v128, v129
    v_mfma_f32_16x16x32_bf16 v[180:183], v[224:227], a[12:15], 0
    v_cvt_pk_bf16_f32 v121, v130, v131
    s_waitcnt vmcnt(10) lgkmcnt(0)
    s_barrier
    v_mfma_f32_16x16x32_bf16 v[184:187], v[244:247], a[16:19], v[184:187]
    ds_read_b64_tr_b16 v[228:229], v32 offset:33792
    v_cvt_pk_bf16_f32 v122, v132, v133
    v_cvt_pk_bf16_f32 v123, v134, v135
    v_mfma_f32_16x16x32_bf16 v[188:191], v[244:247], a[20:23], v[188:191]
    ds_read_b64_tr_b16 v[230:231], v32 offset:34304
    buffer_load_dwordx4 v8, s[28:31], s79 offen offset:1024 lds
    v_mfma_f32_16x16x32_bf16 v[192:195], v[244:247], a[24:27], v[192:195]
    ds_read_b64_tr_b16 v[232:233], v32 offset:34816
    v_cvt_pk_bf16_f32 v124, v136, v137
    v_mfma_f32_16x16x32_bf16 v[196:199], v[244:247], a[28:31], v[196:199]
    ds_read_b64_tr_b16 v[234:235], v32 offset:35328
    buffer_load_dwordx4 v8, s[28:31], s79 offen offset:2048 lds
    v_mfma_f32_16x16x32_bf16 v[204:207], a[16:19], v[248:251], v[204:207]
    ds_read_b128 v[236:239], v17 offset:2048
    v_cvt_pk_bf16_f32 v125, v138, v139
    v_mfma_f32_16x16x32_bf16 v[208:211], a[20:23], v[248:251], v[208:211]
    ds_read_b64_tr_b16 v[224:225], v32 offset:32768
    s_add_u32 m0, s94, 65536
    v_cvt_pk_bf16_f32 v126, v140, v141
    v_mfma_f32_16x16x32_bf16 v[212:215], a[24:27], v[248:251], v[212:215]
    ds_read_b64_tr_b16 v[226:227], v32 offset:33280
    buffer_load_dwordx4 v0, s[28:31], s79 offen offset:0 lds
    v_mfma_f32_16x16x32_bf16 v[216:219], a[28:31], v[248:251], v[216:219]
    v_cvt_pk_bf16_f32 v127, v142, v143
    v_mfma_f32_16x16x32_bf16 v[200:203], v[244:247], v[252:255], v[200:203]
    buffer_load_dwordx4 v0, s[28:31], s79 offen offset:1024 lds
    v_mfma_f32_16x16x32_bf16 v[220:223], v[252:255], v[248:251], v[220:223]
    v_permlane16_swap_b32 v120, v122
    v_mfma_f32_16x16x32_bf16 v[168:171], v[240:243], a[16:19], v[168:171]
    v_permlane16_swap_b32 v121, v123
    v_mfma_f32_16x16x32_bf16 v[172:175], v[240:243], a[20:23], v[172:175]
    buffer_load_dwordx4 v0, s[28:31], s79 offen offset:2048 lds
    v_mfma_f32_16x16x32_bf16 v[176:179], v[240:243], a[24:27], v[176:179]
    v_permlane16_swap_b32 v124, v126
    v_mfma_f32_16x16x32_bf16 v[180:183], v[240:243], a[28:31], v[180:183]
    v_permlane16_swap_b32 v125, v127
    s_waitcnt vmcnt(9) lgkmcnt(0)
    s_barrier
    v_mfma_f32_16x16x32_bf16 v[184:187], v[228:231], a[32:35], v[184:187]
    ds_read_b64_tr_b16 v[244:245], v32 offset:46080
    s_add_u32 m0, s94, 77824
    s_mov_b32 s72, 3216550459
    v_add_f32 v144, v144, v146
    v_mfma_f32_16x16x32_bf16 v[188:191], v[228:231], a[36:39], v[188:191]
    ds_read_b64_tr_b16 v[246:247], v32 offset:46592
    buffer_load_dwordx4 v8, s[28:31], s80 offen offset:0 lds
    v_mfma_f32_16x16x32_bf16 v[192:195], v[228:231], a[40:43], v[192:195]
    ds_read_b64_tr_b16 v[248:249], v32 offset:47104
    v_add_f32 v148, v148, v150
    v_mfma_f32_16x16x32_bf16 v[196:199], v[228:231], a[44:47], v[196:199]
    ds_read_b64_tr_b16 v[250:251], v32 offset:47616
    buffer_load_dwordx4 v8, s[28:31], s80 offen offset:1024 lds
    v_mfma_f32_16x16x32_bf16 v[204:207], a[32:35], v[232:235], v[204:207]
    ds_read_b128 v[252:255], v18 offset:2048
    v_add_f32 v152, v152, v154
    v_mfma_f32_16x16x32_bf16 v[208:211], a[36:39], v[232:235], v[208:211]
    ds_read_b64_tr_b16 v[240:241], v32 offset:45056
    buffer_load_dwordx4 v8, s[28:31], s80 offen offset:2048 lds
    v_mfma_f32_16x16x32_bf16 v[212:215], a[40:43], v[232:235], v[212:215]
    ds_read_b64_tr_b16 v[242:243], v32 offset:45568
    s_add_u32 m0, s94, 36864
    v_add_f32 v156, v156, v158
    v_mfma_f32_16x16x32_bf16 v[216:219], a[44:47], v[232:235], v[216:219]
    buffer_load_dwordx4 v0, s[28:31], s80 offen offset:0 lds
    v_mfma_f32_16x16x32_bf16 v[200:203], v[228:231], v[236:239], v[200:203]
    v_add_f32 v145, v145, v147
    v_add_f32 v149, v149, v151
    v_mfma_f32_16x16x32_bf16 v[220:223], v[236:239], v[232:235], v[220:223]
    buffer_load_dwordx4 v0, s[28:31], s80 offen offset:1024 lds
    v_mfma_f32_16x16x32_bf16 v[168:171], v[224:227], a[32:35], v[168:171]
    v_add_f32 v153, v153, v155
    v_mfma_f32_16x16x32_bf16 v[172:175], v[224:227], a[36:39], v[172:175]
    buffer_load_dwordx4 v0, s[28:31], s80 offen offset:2048 lds
    v_mfma_f32_16x16x32_bf16 v[176:179], v[224:227], a[40:43], v[176:179]
    v_add_f32 v157, v157, v159
    v_mfma_f32_16x16x32_bf16 v[180:183], v[224:227], a[44:47], v[180:183]
    v_add_f32 v144, v144, v145
    s_mov_b64 exec, 1
    buffer_store_dwordx2 v[34:35], off, s[40:43], s97 sc1
    s_mov_b64 exec, -1
    s_waitcnt lgkmcnt(0)
    v_mfma_f32_16x16x32_bf16 v[184:187], v[244:247], a[48:51], v[184:187]
    ds_read_b64_tr_b16 v[228:229], v14 offset:1024
    s_add_u32 m0, s94, 49152
    v_add_f32 v148, v148, v149
    v_mfma_f32_16x16x32_bf16 v[188:191], v[244:247], a[52:55], v[188:191]
    ds_read_b64_tr_b16 v[230:231], v14 offset:1536
    buffer_load_dwordx4 v8, s[28:31], s81 offen offset:0 lds
    v_mfma_f32_16x16x32_bf16 v[192:195], v[244:247], a[56:59], v[192:195]
    ds_read_b64_tr_b16 v[232:233], v14 offset:2048
    v_add_f32 v152, v152, v153
    v_mfma_f32_16x16x32_bf16 v[196:199], v[244:247], a[60:63], v[196:199]
    ds_read_b64_tr_b16 v[234:235], v14 offset:2560
    v_add_f32 v156, v156, v157
    v_mfma_f32_16x16x32_bf16 v[204:207], a[48:51], v[248:251], v[204:207]
    ds_read_b128 v[236:239], v17 offset:4096
    v_mul_f32 v144, s72, v144
    v_mfma_f32_16x16x32_bf16 v[208:211], a[52:55], v[248:251], v[208:211]
    ds_read_b64_tr_b16 v[224:225], v14 offset:0
    buffer_load_dwordx4 v8, s[28:31], s81 offen offset:1024 lds
    v_mfma_f32_16x16x32_bf16 v[212:215], a[56:59], v[248:251], v[212:215]
    ds_read_b64_tr_b16 v[226:227], v14 offset:512
    v_mul_f32 v148, s72, v148
    v_mfma_f32_16x16x32_bf16 v[216:219], a[60:63], v[248:251], v[216:219]
    v_mul_f32 v152, s72, v152
    v_mfma_f32_16x16x32_bf16 v[200:203], v[244:247], v[252:255], v[200:203]
    v_mul_f32 v156, s72, v156
    v_mfma_f32_16x16x32_bf16 v[220:223], v[252:255], v[248:251], v[220:223]
    buffer_load_dwordx4 v8, s[28:31], s81 offen offset:2048 lds
    v_mfma_f32_16x16x32_bf16 v[168:171], v[240:243], a[48:51], v[168:171]
    v_exp_f32 v144, v144
    v_mfma_f32_16x16x32_bf16 v[172:175], v[240:243], a[52:55], v[172:175]
    v_exp_f32 v148, v148
    v_mfma_f32_16x16x32_bf16 v[176:179], v[240:243], a[56:59], v[176:179]
    v_exp_f32 v152, v152
    v_mfma_f32_16x16x32_bf16 v[180:183], v[240:243], a[60:63], v[180:183]
    s_waitcnt vmcnt(13) lgkmcnt(0)
    s_barrier
    v_mfma_f32_16x16x32_bf16 v[184:187], v[228:231], a[64:67], v[184:187]
    ds_read_b64_tr_b16 v[244:245], v14 offset:13312
    s_add_u32 m0, s94, 90112
    v_exp_f32 v156, v156
    v_mfma_f32_16x16x32_bf16 v[188:191], v[228:231], a[68:71], v[188:191]
    ds_read_b64_tr_b16 v[246:247], v14 offset:13824
    buffer_load_dwordx4 v0, s[28:31], s81 offen offset:0 lds
    v_mfma_f32_16x16x32_bf16 v[192:195], v[228:231], a[72:75], v[192:195]
    ds_read_b64_tr_b16 v[248:249], v14 offset:14336
    v_add_f32 v144, 1.0, v144
    v_mfma_f32_16x16x32_bf16 v[196:199], v[228:231], a[76:79], v[196:199]
    ds_read_b64_tr_b16 v[250:251], v14 offset:14848
    v_add_f32 v148, 1.0, v148
    v_mfma_f32_16x16x32_bf16 v[204:207], a[64:67], v[232:235], v[204:207]
    ds_read_b128 v[252:255], v18 offset:4096
    v_add_f32 v152, 1.0, v152
    v_mfma_f32_16x16x32_bf16 v[208:211], a[68:71], v[232:235], v[208:211]
    ds_read_b64_tr_b16 v[240:241], v14 offset:12288
    buffer_load_dwordx4 v0, s[28:31], s81 offen offset:1024 lds
    v_mfma_f32_16x16x32_bf16 v[212:215], a[72:75], v[232:235], v[212:215]
    ds_read_b64_tr_b16 v[242:243], v14 offset:12800
    v_add_f32 v156, 1.0, v156
    v_mfma_f32_16x16x32_bf16 v[216:219], a[76:79], v[232:235], v[216:219]
    v_rcp_f32 v144, v144
    v_mfma_f32_16x16x32_bf16 v[200:203], v[228:231], v[236:239], v[200:203]
    v_rcp_f32 v148, v148
    v_mfma_f32_16x16x32_bf16 v[220:223], v[236:239], v[232:235], v[220:223]
    buffer_load_dwordx4 v0, s[28:31], s81 offen offset:2048 lds
    v_mfma_f32_16x16x32_bf16 v[168:171], v[224:227], a[64:67], v[168:171]
    v_rcp_f32 v152, v152
    v_mfma_f32_16x16x32_bf16 v[172:175], v[224:227], a[68:71], v[172:175]
    v_rcp_f32 v156, v156
    v_mfma_f32_16x16x32_bf16 v[176:179], v[224:227], a[72:75], v[176:179]
    s_not_b64 s[60:61], s[62:63]
    v_mfma_f32_16x16x32_bf16 v[180:183], v[224:227], a[76:79], v[180:183]
    s_waitcnt lgkmcnt(0)
    v_mfma_f32_16x16x32_bf16 v[184:187], v[244:247], a[80:83], v[184:187]
    ds_read_b64_tr_b16 v[228:229], v14 offset:25600
    s_add_u32 m0, s94, 102400
    v_sub_f32 v38, 1.0, v144
    v_mfma_f32_16x16x32_bf16 v[188:191], v[244:247], a[84:87], v[188:191]
    ds_read_b64_tr_b16 v[230:231], v14 offset:26112
    buffer_load_dwordx4 v8, s[28:31], s82 offen offset:0 lds
    v_mfma_f32_16x16x32_bf16 v[192:195], v[244:247], a[88:91], v[192:195]
    ds_read_b64_tr_b16 v[232:233], v14 offset:26624
    v_sub_f32 v39, 1.0, v148
    v_mfma_f32_16x16x32_bf16 v[196:199], v[244:247], a[92:95], v[196:199]
    ds_read_b64_tr_b16 v[234:235], v14 offset:27136
    v_sub_f32 v40, 1.0, v152
    v_mfma_f32_16x16x32_bf16 v[204:207], a[80:83], v[248:251], v[204:207]
    ds_read_b128 v[236:239], v17 offset:6144
    v_sub_f32 v41, 1.0, v156
    v_mfma_f32_16x16x32_bf16 v[208:211], a[84:87], v[248:251], v[208:211]
    ds_read_b64_tr_b16 v[224:225], v14 offset:24576
    buffer_load_dwordx4 v8, s[28:31], s82 offen offset:1024 lds
    v_mfma_f32_16x16x32_bf16 v[212:215], a[88:91], v[248:251], v[212:215]
    ds_read_b64_tr_b16 v[226:227], v14 offset:25088
    v_cndmask_b32 v42, v144, v148, s[60:61]
    v_mfma_f32_16x16x32_bf16 v[216:219], a[92:95], v[248:251], v[216:219]
    v_cndmask_b32 v43, v152, v156, s[60:61]
    v_mfma_f32_16x16x32_bf16 v[200:203], v[244:247], v[252:255], v[200:203]
    v_and_b32 v160, s88, v33
    v_mfma_f32_16x16x32_bf16 v[220:223], v[252:255], v[248:251], v[220:223]
    buffer_load_dwordx4 v8, s[28:31], s82 offen offset:2048 lds
    v_mfma_f32_16x16x32_bf16 v[168:171], v[240:243], a[80:83], v[168:171]
    v_and_b32 v161, s89, v33
    v_mfma_f32_16x16x32_bf16 v[172:175], v[240:243], a[84:87], v[172:175]
    v_and_b32 v162, s90, v33
    v_mfma_f32_16x16x32_bf16 v[176:179], v[240:243], a[88:91], v[176:179]
    v_and_b32 v163, s91, v33
    v_mfma_f32_16x16x32_bf16 v[180:183], v[240:243], a[92:95], v[180:183]
    s_waitcnt vmcnt(13) lgkmcnt(0)
    s_barrier
    v_mfma_f32_16x16x32_bf16 v[184:187], v[228:231], a[96:99], v[184:187]
    ds_read_b64_tr_b16 v[244:245], v32 offset:1024
    s_add_u32 m0, s94, 114688
    v_accvgpr_write_b32 a4, v163
    v_accvgpr_write_b32 a5, v163
    v_mfma_f32_16x16x32_bf16 v[188:191], v[228:231], a[100:103], v[188:191]
    ds_read_b64_tr_b16 v[246:247], v32 offset:1536
    buffer_load_dwordx4 v0, s[28:31], s82 offen offset:0 lds
    v_mfma_f32_16x16x32_bf16 v[192:195], v[228:231], a[104:107], v[192:195]
    ds_read_b64_tr_b16 v[248:249], v32 offset:2048
    v_accvgpr_write_b32 a6, v163
    v_accvgpr_write_b32 a7, v163
    v_mfma_f32_16x16x32_bf16 v[196:199], v[228:231], a[108:111], v[196:199]
    ds_read_b64_tr_b16 v[250:251], v32 offset:2560
    v_accvgpr_write_b32 a8, v163
    v_accvgpr_write_b32 a9, v163
    v_mfma_f32_16x16x32_bf16 v[204:207], a[96:99], v[232:235], v[204:207]
    ds_read_b128 v[252:255], v18 offset:6144
    v_accvgpr_write_b32 a10, v163
    v_accvgpr_write_b32 a11, v163
    v_mfma_f32_16x16x32_bf16 v[208:211], a[100:103], v[232:235], v[208:211]
    ds_read_b64_tr_b16 v[240:241], v32 offset:0
    v_accvgpr_write_b32 a16, v163
    v_accvgpr_write_b32 a17, v163
    v_mfma_f32_16x16x32_bf16 v[212:215], a[104:107], v[232:235], v[212:215]
    ds_read_b64_tr_b16 v[242:243], v32 offset:512
    s_sub_u32 s12, s97, 32
    v_mfma_f32_16x16x32_bf16 v[216:219], a[108:111], v[232:235], v[216:219]
    buffer_load_dwordx4 v0, s[28:31], s82 offen offset:1024 lds
    v_mfma_f32_16x16x32_bf16 v[200:203], v[228:231], v[236:239], v[200:203]
    s_mul_i32 s71, s66, 69632
    s_lshr_b32 s72, s67, 1
    v_mfma_f32_16x16x32_bf16 v[220:223], v[236:239], v[232:235], v[220:223]
    s_lshl_b32 s72, s72, 15
    s_add_u32 s71, s71, s72
    v_mfma_f32_16x16x32_bf16 v[168:171], v[224:227], a[96:99], v[168:171]
    s_and_b32 s72, s67, 1
    s_lshl_b32 s72, s72, 12
    v_mfma_f32_16x16x32_bf16 v[172:175], v[224:227], a[100:103], v[172:175]
    s_add_u32 s71, s71, s72
    s_lshr_b32 s65, s65, 1
    v_mfma_f32_16x16x32_bf16 v[176:179], v[224:227], a[104:107], v[176:179]
    s_mov_b32 s93, s65
    s_add_u32 s72, s93, 0
    v_mfma_f32_16x16x32_bf16 v[180:183], v[224:227], a[108:111], v[180:183]
    s_and_b32 s72, s72, 3
    s_waitcnt lgkmcnt(0)
    v_mfma_f32_16x16x32_bf16 v[184:187], v[244:247], a[112:115], v[184:187]
    ds_read_b64_tr_b16 v[228:229], v32 offset:13312
    v_accvgpr_write_b32 a18, v163
    v_accvgpr_write_b32 a19, v163
    v_mfma_f32_16x16x32_bf16 v[188:191], v[244:247], a[116:119], v[188:191]
    ds_read_b64_tr_b16 v[230:231], v32 offset:13824
    buffer_load_dwordx4 v0, s[28:31], s82 offen offset:2048 lds
    v_mfma_f32_16x16x32_bf16 v[192:195], v[244:247], a[120:123], v[192:195]
    ds_read_b64_tr_b16 v[232:233], v32 offset:14336
    v_accvgpr_write_b32 a20, v163
    v_accvgpr_write_b32 a21, v163
    v_mfma_f32_16x16x32_bf16 v[196:199], v[244:247], a[124:127], v[196:199]
    ds_read_b64_tr_b16 v[234:235], v32 offset:14848
    v_accvgpr_write_b32 a22, v163
    v_accvgpr_write_b32 a23, v163
    v_mfma_f32_16x16x32_bf16 v[204:207], a[112:115], v[248:251], v[204:207]
    ds_read_b128 v[236:239], v17 offset:8192
    s_add_u32 m0, s94, 0
    v_accvgpr_write_b32 a28, v162
    v_accvgpr_write_b32 a29, v162
    v_mfma_f32_16x16x32_bf16 v[208:211], a[116:119], v[248:251], v[208:211]
    ds_read_b64_tr_b16 v[224:225], v32 offset:12288
    buffer_load_dwordx4 v8, s[28:31], s83 offen offset:0 lds
    v_mfma_f32_16x16x32_bf16 v[212:215], a[120:123], v[248:251], v[212:215]
    ds_read_b64_tr_b16 v[226:227], v32 offset:12800
    v_accvgpr_write_b32 a30, v162
    v_accvgpr_write_b32 a31, v162
    v_mfma_f32_16x16x32_bf16 v[216:219], a[124:127], v[248:251], v[216:219]
    s_lshl_b32 s72, s72, 13
    s_add_u32 s72, s72, s71
    v_mfma_f32_16x16x32_bf16 v[200:203], v[244:247], v[252:255], v[200:203]
    s_add_u32 s20, s72, 5242880
    s_add_u32 s24, s72, 8388608
    v_mfma_f32_16x16x32_bf16 v[220:223], v[252:255], v[248:251], v[220:223]
    buffer_load_dwordx4 v8, s[28:31], s83 offen offset:1024 lds
    v_mfma_f32_16x16x32_bf16 v[168:171], v[240:243], a[112:115], v[168:171]
    s_add_u32 s72, s93, 1
    s_and_b32 s72, s72, 3
    v_mfma_f32_16x16x32_bf16 v[172:175], v[240:243], a[116:119], v[172:175]
    s_lshl_b32 s72, s72, 13
    s_add_u32 s72, s72, s71
    v_mfma_f32_16x16x32_bf16 v[176:179], v[240:243], a[120:123], v[176:179]
    s_add_u32 s21, s72, 5242880
    s_add_u32 s25, s72, 8388608
    v_mfma_f32_16x16x32_bf16 v[180:183], v[240:243], a[124:127], v[180:183]
    s_add_u32 s72, s93, 2
    s_and_b32 s72, s72, 3
    s_waitcnt vmcnt(11) lgkmcnt(0)
    s_barrier
    s_buffer_load_dwordx8 s[4:11], s[40:43], s12 glc
    v_mfma_f32_16x16x32_bf16 v[184:187], v[228:231], a[128:131], v[184:187]
    ds_read_b64_tr_b16 v[244:245], v14 offset:37888
    v_accvgpr_write_b32 a32, v162
    v_accvgpr_write_b32 a33, v162
    v_mfma_f32_16x16x32_bf16 v[188:191], v[228:231], a[132:135], v[188:191]
    ds_read_b64_tr_b16 v[246:247], v14 offset:38400
    buffer_load_dwordx4 v8, s[28:31], s83 offen offset:2048 lds
    v_mfma_f32_16x16x32_bf16 v[192:195], v[228:231], a[136:139], v[192:195]
    ds_read_b64_tr_b16 v[248:249], v14 offset:38912
    v_accvgpr_write_b32 a34, v162
    v_accvgpr_write_b32 a35, v162
    v_mfma_f32_16x16x32_bf16 v[196:199], v[228:231], a[140:143], v[196:199]
    ds_read_b64_tr_b16 v[250:251], v14 offset:39424
    v_accvgpr_write_b32 a40, v162
    v_accvgpr_write_b32 a41, v162
    v_mfma_f32_16x16x32_bf16 v[204:207], a[128:131], v[232:235], v[204:207]
    ds_read_b128 v[252:255], v18 offset:8192
    s_add_u32 m0, s94, 65536
    v_accvgpr_write_b32 a42, v162
    v_accvgpr_write_b32 a43, v162
    v_mfma_f32_16x16x32_bf16 v[208:211], a[132:135], v[232:235], v[208:211]
    ds_read_b64_tr_b16 v[240:241], v14 offset:36864
    buffer_load_dwordx4 v0, s[28:31], s83 offen offset:0 lds
    v_mfma_f32_16x16x32_bf16 v[212:215], a[136:139], v[232:235], v[212:215]
    ds_read_b64_tr_b16 v[242:243], v14 offset:37376
    v_accvgpr_write_b32 a44, v162
    v_accvgpr_write_b32 a45, v162
    v_mfma_f32_16x16x32_bf16 v[216:219], a[140:143], v[232:235], v[216:219]
    s_lshl_b32 s72, s72, 13
    s_add_u32 s72, s72, s71
    v_mfma_f32_16x16x32_bf16 v[200:203], v[228:231], v[236:239], v[200:203]
    s_add_u32 s22, s72, 5242880
    s_add_u32 s26, s72, 8388608
    v_mfma_f32_16x16x32_bf16 v[220:223], v[236:239], v[232:235], v[220:223]
    buffer_load_dwordx4 v0, s[28:31], s83 offen offset:1024 lds
    v_mfma_f32_16x16x32_bf16 v[168:171], v[224:227], a[128:131], v[168:171]
    s_add_u32 s72, s93, 3
    s_and_b32 s72, s72, 3
    v_mfma_f32_16x16x32_bf16 v[172:175], v[224:227], a[132:135], v[172:175]
    s_lshl_b32 s72, s72, 13
    s_add_u32 s72, s72, s71
    v_mfma_f32_16x16x32_bf16 v[176:179], v[224:227], a[136:139], v[176:179]
    s_add_u32 s23, s72, 5242880
    s_add_u32 s27, s72, 8388608
    v_mfma_f32_16x16x32_bf16 v[180:183], v[224:227], a[140:143], v[180:183]
    s_lshl_b32 s74, s66, 8
    s_add_u32 s74, s74, 11796480
    s_waitcnt lgkmcnt(5)
    v_mfma_f32_16x16x32_bf16 v[184:187], v[244:247], a[144:147], v[184:187]
    ds_read_b64_tr_b16 v[228:229], v14 offset:50176
    v_accvgpr_write_b32 a46, v162
    v_accvgpr_write_b32 a47, v162
    v_mfma_f32_16x16x32_bf16 v[188:191], v[244:247], a[148:151], v[188:191]
    ds_read_b64_tr_b16 v[230:231], v14 offset:50688
    buffer_load_dwordx4 v0, s[28:31], s83 offen offset:2048 lds
    v_mfma_f32_16x16x32_bf16 v[192:195], v[244:247], a[152:155], v[192:195]
    ds_read_b64_tr_b16 v[232:233], v14 offset:51200
    v_accvgpr_write_b32 a52, v161
    v_mfma_f32_16x16x32_bf16 v[196:199], v[244:247], a[156:159], v[196:199]
    ds_read_b64_tr_b16 v[234:235], v14 offset:51712
    v_accvgpr_write_b32 a53, v161
    v_accvgpr_write_b32 a54, v161
    s_waitcnt lgkmcnt(7)
    v_mfma_f32_16x16x32_bf16 v[204:207], a[144:147], v[248:251], v[204:207]
    ds_read_b128 v[236:239], v17 offset:10240
    v_accvgpr_write_b32 a55, v161
    v_mfma_f32_16x16x32_bf16 v[208:211], a[148:151], v[248:251], v[208:211]
    ds_read_b64_tr_b16 v[224:225], v14 offset:49152
    v_accvgpr_write_b32 a56, v161
    v_accvgpr_write_b32 a57, v161
    v_mfma_f32_16x16x32_bf16 v[212:215], a[152:155], v[248:251], v[212:215]
    ds_read_b64_tr_b16 v[226:227], v14 offset:49664
    v_accvgpr_write_b32 a58, v161
    v_mfma_f32_16x16x32_bf16 v[216:219], a[156:159], v[248:251], v[216:219]
    v_accvgpr_write_b32 a59, v161
    s_lshl_b32 s71, s64, 3
    s_waitcnt lgkmcnt(9)
    v_mfma_f32_16x16x32_bf16 v[200:203], v[244:247], v[252:255], v[200:203]
    s_add_u32 s70, s74, s71
    v_mfma_f32_16x16x32_bf16 v[220:223], v[252:255], v[248:251], v[220:223]
    s_add_u32 s68, s70, 262144
    s_add_u32 s73, s74, 262144
    s_waitcnt lgkmcnt(7)
    v_mfma_f32_16x16x32_bf16 v[168:171], v[240:243], a[144:147], v[168:171]
    s_lshl_b32 s71, s2, 2
    v_mfma_f32_16x16x32_bf16 v[172:175], v[240:243], a[148:151], v[172:175]
    s_add_u32 s71, s71, s67
    s_lshl_b32 s71, s71, 7
    v_mfma_f32_16x16x32_bf16 v[176:179], v[240:243], a[152:155], v[176:179]
    s_add_u32 s71, s71, 12320768
    v_mfma_f32_16x16x32_bf16 v[180:183], v[240:243], a[156:159], v[180:183]
    s_cmp_eq_u32 s67, 0
    s_cselect_b32 s70, s70, s71
    s_cselect_b32 s68, s68, s71
    s_waitcnt vmcnt(9)
    s_barrier
    s_waitcnt lgkmcnt(5)
    v_mfma_f32_16x16x32_bf16 v[184:187], v[228:231], a[160:163], v[184:187]
    ds_read_b64_tr_b16 v[244:245], v32 offset:25600
    v_accvgpr_write_b32 a64, v161
    v_mfma_f32_16x16x32_bf16 v[188:191], v[228:231], a[164:167], v[188:191]
    ds_read_b64_tr_b16 v[246:247], v32 offset:26112
    v_accvgpr_write_b32 a65, v161
    v_mfma_f32_16x16x32_bf16 v[192:195], v[228:231], a[168:171], v[192:195]
    ds_read_b64_tr_b16 v[248:249], v32 offset:26624
    v_accvgpr_write_b32 a66, v161
    v_mfma_f32_16x16x32_bf16 v[196:199], v[228:231], a[172:175], v[196:199]
    ds_read_b64_tr_b16 v[250:251], v32 offset:27136
    s_waitcnt lgkmcnt(7)
    v_mfma_f32_16x16x32_bf16 v[204:207], a[160:163], v[232:235], v[204:207]
    ds_read_b128 v[252:255], v18 offset:10240
    v_accvgpr_write_b32 a67, v161
    v_mfma_f32_16x16x32_bf16 v[208:211], a[164:167], v[232:235], v[208:211]
    ds_read_b64_tr_b16 v[240:241], v32 offset:24576
    v_accvgpr_write_b32 a68, v161
    v_mfma_f32_16x16x32_bf16 v[212:215], a[168:171], v[232:235], v[212:215]
    ds_read_b64_tr_b16 v[242:243], v32 offset:25088
    v_mfma_f32_16x16x32_bf16 v[216:219], a[172:175], v[232:235], v[216:219]
    v_accvgpr_write_b32 a69, v161
    s_waitcnt lgkmcnt(9)
    v_mfma_f32_16x16x32_bf16 v[200:203], v[228:231], v[236:239], v[200:203]
    v_accvgpr_write_b32 a70, v161
    v_mfma_f32_16x16x32_bf16 v[220:223], v[236:239], v[232:235], v[220:223]
    v_accvgpr_write_b32 a71, v161
    s_waitcnt lgkmcnt(7)
    v_mfma_f32_16x16x32_bf16 v[168:171], v[224:227], a[160:163], v[168:171]
    v_mfma_f32_16x16x32_bf16 v[172:175], v[224:227], a[164:167], v[172:175]
    v_accvgpr_write_b32 a76, v160
    v_mfma_f32_16x16x32_bf16 v[176:179], v[224:227], a[168:171], v[176:179]
    v_accvgpr_write_b32 a77, v160
    v_mfma_f32_16x16x32_bf16 v[180:183], v[224:227], a[172:175], v[180:183]
    s_waitcnt lgkmcnt(5)
    v_mfma_f32_16x16x32_bf16 v[184:187], v[244:247], a[176:179], v[184:187]
    ds_read_b64_tr_b16 v[228:229], v32 offset:37888
    v_accvgpr_write_b32 a78, v160
    v_mfma_f32_16x16x32_bf16 v[188:191], v[244:247], a[180:183], v[188:191]
    ds_read_b64_tr_b16 v[230:231], v32 offset:38400
    v_accvgpr_write_b32 a79, v160
    v_mfma_f32_16x16x32_bf16 v[192:195], v[244:247], a[184:187], v[192:195]
    ds_read_b64_tr_b16 v[232:233], v32 offset:38912
    v_accvgpr_write_b32 a80, v160
    v_mfma_f32_16x16x32_bf16 v[196:199], v[244:247], a[188:191], v[196:199]
    ds_read_b64_tr_b16 v[234:235], v32 offset:39424
    s_waitcnt lgkmcnt(7)
    v_mfma_f32_16x16x32_bf16 v[204:207], a[176:179], v[248:251], v[204:207]
    ds_read_b128 v[236:239], v17 offset:12288
    v_accvgpr_write_b32 a81, v160
    v_mfma_f32_16x16x32_bf16 v[208:211], a[180:183], v[248:251], v[208:211]
    ds_read_b64_tr_b16 v[224:225], v32 offset:36864
    v_accvgpr_write_b32 a82, v160
    v_mfma_f32_16x16x32_bf16 v[212:215], a[184:187], v[248:251], v[212:215]
    ds_read_b64_tr_b16 v[226:227], v32 offset:37376
    v_mfma_f32_16x16x32_bf16 v[216:219], a[188:191], v[248:251], v[216:219]
    v_accvgpr_write_b32 a83, v160
    s_waitcnt lgkmcnt(9)
    v_mfma_f32_16x16x32_bf16 v[200:203], v[244:247], v[252:255], v[200:203]
    v_accvgpr_write_b32 a88, v160
    v_mfma_f32_16x16x32_bf16 v[220:223], v[252:255], v[248:251], v[220:223]
    v_accvgpr_write_b32 a89, v160
    s_waitcnt lgkmcnt(7)
    v_mfma_f32_16x16x32_bf16 v[168:171], v[240:243], a[176:179], v[168:171]
    v_mfma_f32_16x16x32_bf16 v[172:175], v[240:243], a[180:183], v[172:175]
    v_accvgpr_write_b32 a90, v160
    v_mfma_f32_16x16x32_bf16 v[176:179], v[240:243], a[184:187], v[176:179]
    v_accvgpr_write_b32 a91, v160
    v_mfma_f32_16x16x32_bf16 v[180:183], v[240:243], a[188:191], v[180:183]
    s_waitcnt vmcnt(3)
    s_barrier
    s_waitcnt lgkmcnt(5)
    v_mfma_f32_16x16x32_bf16 v[184:187], v[228:231], a[192:195], v[184:187]
    ds_read_b64_tr_b16 v[244:245], v32 offset:50176
    v_accvgpr_write_b32 a92, v160
    v_mfma_f32_16x16x32_bf16 v[188:191], v[228:231], a[196:199], v[188:191]
    ds_read_b64_tr_b16 v[246:247], v32 offset:50688
    v_mfma_f32_16x16x32_bf16 v[192:195], v[228:231], a[200:203], v[192:195]
    ds_read_b64_tr_b16 v[248:249], v32 offset:51200
    v_mfma_f32_16x16x32_bf16 v[196:199], v[228:231], a[204:207], v[196:199]
    ds_read_b64_tr_b16 v[250:251], v32 offset:51712
    v_accvgpr_write_b32 a93, v160
    s_waitcnt lgkmcnt(7)
    v_mfma_f32_16x16x32_bf16 v[204:207], a[192:195], v[232:235], v[204:207]
    ds_read_b128 v[252:255], v18 offset:12288
    v_mfma_f32_16x16x32_bf16 v[208:211], a[196:199], v[232:235], v[208:211]
    ds_read_b64_tr_b16 v[240:241], v32 offset:49152
    v_mfma_f32_16x16x32_bf16 v[212:215], a[200:203], v[232:235], v[212:215]
    ds_read_b64_tr_b16 v[242:243], v32 offset:49664
    v_mfma_f32_16x16x32_bf16 v[216:219], a[204:207], v[232:235], v[216:219]
    v_accvgpr_write_b32 a94, v160
    s_waitcnt lgkmcnt(9)
    v_mfma_f32_16x16x32_bf16 v[200:203], v[228:231], v[236:239], v[200:203]
    v_mfma_f32_16x16x32_bf16 v[220:223], v[236:239], v[232:235], v[220:223]
    s_waitcnt lgkmcnt(7)
    v_mfma_f32_16x16x32_bf16 v[168:171], v[224:227], a[192:195], v[168:171]
    v_accvgpr_write_b32 a95, v160
    v_mfma_f32_16x16x32_bf16 v[172:175], v[224:227], a[196:199], v[172:175]
    v_mfma_f32_16x16x32_bf16 v[176:179], v[224:227], a[200:203], v[176:179]
    v_mfma_f32_16x16x32_bf16 v[180:183], v[224:227], a[204:207], v[180:183]
    s_waitcnt lgkmcnt(0)
L_h1:
    s_xor_b64 s[4:5], s[4:5], s[48:49]
    s_xor_b64 s[6:7], s[6:7], s[48:49]
    s_xor_b64 s[8:9], s[8:9], s[48:49]
    s_xor_b64 s[10:11], s[10:11], s[48:49]
    s_cmp_ge_u32 s66, 4
    s_cselect_b64 s[4:5], s[4:5], 0
    s_cmp_ge_u32 s66, 3
    s_cselect_b64 s[6:7], s[6:7], 0
    s_cmp_ge_u32 s66, 2
    s_cselect_b64 s[8:9], s[8:9], 0
    s_cmp_ge_u32 s66, 1
    s_cselect_b64 s[10:11], s[10:11], 0
    s_or_b64 s[4:5], s[4:5], s[6:7]
    s_or_b64 s[8:9], s[8:9], s[10:11]
    s_or_b64 s[4:5], s[4:5], s[8:9]
    s_cbranch_scc1 L_h1r
L_h1ok:
    v_mfma_f32_16x16x32_bf16 v[184:187], v[244:247], a[208:211], v[184:187]
    ds_read_b64_tr_b16 v[228:229], v14 offset:1024
    v_mfma_f32_16x16x32_bf16 v[188:191], v[244:247], a[212:215], v[188:191]
    ds_read_b64_tr_b16 v[230:231], v14 offset:1536
    buffer_load_dwordx4 a[0:3], v20, s[40:43], s87 offen offset:2048 sc1
    v_mfma_f32_16x16x32_bf16 v[192:195], v[244:247], a[216:219], v[192:195]
    ds_read_b64_tr_b16 v[232:233], v14 offset:2048
    v_mfma_f32_16x16x32_bf16 v[196:199], v[244:247], a[220:223], v[196:199]
    ds_read_b64_tr_b16 v[234:235], v14 offset:2560
    v_mfma_f32_16x16x32_bf16 v[204:207], a[208:211], v[248:251], v[204:207]
    ds_read_b128 v[236:239], v17 offset:14336
    v_mfma_f32_16x16x32_bf16 v[208:211], a[212:215], v[248:251], v[208:211]
    ds_read_b64_tr_b16 v[224:225], v14 offset:0
    v_mfma_f32_16x16x32_bf16 v[212:215], a[216:219], v[248:251], v[212:215]
    ds_read_b64_tr_b16 v[226:227], v14 offset:512
    v_mfma_f32_16x16x32_bf16 v[216:219], a[220:223], v[248:251], v[216:219]
    s_mov_b64 exec, s[62:63]
    buffer_load_dwordx4 a[4:7], v21, s[40:43], s87 offen offset:3072 sc1
    buffer_load_dwordx4 a[8:11], v21, s[40:43], s87 offen offset:3584 sc1
    s_mov_b64 exec, -1
    v_mfma_f32_16x16x32_bf16 v[200:203], v[244:247], v[252:255], v[200:203]
    v_mfma_f32_16x16x32_bf16 v[220:223], v[252:255], v[248:251], v[220:223]
    v_mfma_f32_16x16x32_bf16 v[168:171], v[240:243], a[208:211], v[168:171]
    v_mfma_f32_16x16x32_bf16 v[172:175], v[240:243], a[212:215], v[172:175]
    v_mfma_f32_16x16x32_bf16 v[176:179], v[240:243], a[216:219], v[176:179]
    v_mfma_f32_16x16x32_bf16 v[180:183], v[240:243], a[220:223], v[180:183]
    s_waitcnt vmcnt(3) lgkmcnt(0)
    s_barrier
    v_mfma_f32_16x16x32_bf16 v[184:187], v[228:231], a[224:227], v[184:187]
    ds_read_b64_tr_b16 v[244:245], v32 offset:1024
    s_add_u32 s80, s65, 0
    s_sub_u32 s76, s80, s93
    s_and_b32 s76, s76, 3
    s_lshl_b32 s76, s76, 14
    s_add_u32 s81, s65, 1
    s_sub_u32 s77, s81, s93
    s_and_b32 s77, s77, 3
    s_lshl_b32 s77, s77, 14
    v_mfma_f32_16x16x32_bf16 v[188:191], v[228:231], a[228:231], v[188:191]
    ds_read_b64_tr_b16 v[246:247], v32 offset:1536
    buffer_load_dwordx4 a[12:15], v20, s[40:43], s87 offen offset:0 sc1
    v_mfma_f32_16x16x32_bf16 v[192:195], v[228:231], a[232:235], v[192:195]
    ds_read_b64_tr_b16 v[248:249], v32 offset:2048
    s_add_u32 s82, s65, 2
    s_sub_u32 s78, s82, s93
    s_and_b32 s78, s78, 3
    s_lshl_b32 s78, s78, 14
    s_add_u32 s83, s65, 3
    s_sub_u32 s79, s83, s93
    s_and_b32 s79, s79, 3
    s_lshl_b32 s79, s79, 14
    v_mfma_f32_16x16x32_bf16 v[196:199], v[228:231], a[236:239], v[196:199]
    ds_read_b64_tr_b16 v[250:251], v32 offset:2560
    s_add_u32 s76, s76, s95
    s_and_b32 s80, s80, 3
    s_lshl_b32 s80, s80, 17
    v_mfma_f32_16x16x32_bf16 v[204:207], a[224:227], v[232:235], v[204:207]
    ds_read_b128 v[252:255], v18 offset:14336
    s_add_u32 s77, s77, s95
    s_and_b32 s81, s81, 3
    s_lshl_b32 s81, s81, 17
    s_add_u32 s78, s78, s95
    s_and_b32 s82, s82, 3
    s_lshl_b32 s82, s82, 17
    v_mfma_f32_16x16x32_bf16 v[208:211], a[228:231], v[232:235], v[208:211]
    ds_read_b64_tr_b16 v[240:241], v32 offset:0
    s_mov_b64 exec, s[62:63]
    buffer_load_dwordx4 a[16:19], v21, s[40:43], s87 offen offset:1024 sc1
    buffer_load_dwordx4 a[20:23], v21, s[40:43], s87 offen offset:1536 sc1
    s_mov_b64 exec, -1
    v_mfma_f32_16x16x32_bf16 v[212:215], a[232:235], v[232:235], v[212:215]
    ds_read_b64_tr_b16 v[242:243], v32 offset:512
    s_add_u32 s79, s79, s95
    s_and_b32 s83, s83, 3
    s_lshl_b32 s83, s83, 17
    v_mfma_f32_16x16x32_bf16 v[216:219], a[236:239], v[232:235], v[216:219]
    s_mov_b32 s30, s34
    v_lshrrev_b32 v6, 1, v1
    v_mfma_f32_16x16x32_bf16 v[200:203], v[228:231], v[236:239], v[200:203]
    v_or_b32 v6, v6, v1
    v_mfma_f32_16x16x32_bf16 v[220:223], v[236:239], v[232:235], v[220:223]
    buffer_load_dwordx4 a[24:27], v20, s[40:43], s86 offen offset:2048 sc1
    v_mfma_f32_16x16x32_bf16 v[168:171], v[224:227], a[224:227], v[168:171]
    v_and_b32 v6, 1, v6
    v_subrev_u32 v6, 1, v6
    v_mfma_f32_16x16x32_bf16 v[172:175], v[224:227], a[228:231], v[172:175]
    v_and_b32 v6, 1065369472, v6
    v_mfma_f32_16x16x32_bf16 v[176:179], v[224:227], a[232:235], v[176:179]
    v_mov_b32 v7, v6
    v_mov_b32 v8, v6
    v_mfma_f32_16x16x32_bf16 v[180:183], v[224:227], a[236:239], v[180:183]
    v_mov_b32 v9, v6
    s_waitcnt lgkmcnt(0)
    v_mfma_f32_16x16x32_bf16 v[184:187], v[244:247], a[240:243], v[184:187]
    v_mfma_f32_16x16x32_bf16 v[188:191], v[244:247], a[244:247], v[188:191]
    s_mov_b64 exec, s[62:63]
    buffer_load_dwordx4 a[28:31], v21, s[40:43], s86 offen offset:3072 sc1
    buffer_load_dwordx4 a[32:35], v21, s[40:43], s86 offen offset:3584 sc1
    s_mov_b64 exec, -1
    v_mfma_f32_16x16x32_bf16 v[192:195], v[244:247], a[248:251], v[192:195]
    v_mfma_f32_16x16x32_bf16 v[196:199], v[244:247], a[252:255], v[196:199]
    buffer_load_dwordx4 a[36:39], v20, s[40:43], s86 offen offset:0 sc1
    v_mfma_f32_16x16x32_bf16 v[204:207], a[240:243], v[248:251], v[204:207]
    v_mfma_f32_16x16x32_bf16 v[208:211], a[244:247], v[248:251], v[208:211]
    s_mov_b64 exec, s[62:63]
    buffer_load_dwordx4 a[40:43], v21, s[40:43], s86 offen offset:1024 sc1
    buffer_load_dwordx4 a[44:47], v21, s[40:43], s86 offen offset:1536 sc1
    s_mov_b64 exec, -1
    v_mfma_f32_16x16x32_bf16 v[212:215], a[248:251], v[248:251], v[212:215]
    v_mfma_f32_16x16x32_bf16 v[216:219], a[252:255], v[248:251], v[216:219]
    v_mfma_f32_16x16x32_bf16 v[200:203], v[244:247], v[252:255], v[200:203]
    v_cvt_pk_bf16_f32 v136, v184, v185
    v_cvt_pk_bf16_f32 v137, v186, v187
    v_mfma_f32_16x16x32_bf16 v[220:223], v[252:255], v[248:251], v[220:223]
    v_cvt_pk_bf16_f32 v138, v188, v189
    v_cvt_pk_bf16_f32 v139, v190, v191
    v_mfma_f32_16x16x32_bf16 v[168:171], v[240:243], a[240:243], v[168:171]
    v_cvt_pk_bf16_f32 v140, v192, v193
    v_cvt_pk_bf16_f32 v141, v194, v195
    v_mfma_f32_16x16x32_bf16 v[172:175], v[240:243], a[244:247], v[172:175]
    v_cvt_pk_bf16_f32 v142, v196, v197
    v_cvt_pk_bf16_f32 v143, v198, v199
    v_mfma_f32_16x16x32_bf16 v[176:179], v[240:243], a[248:251], v[176:179]
    v_cvt_pk_bf16_f32 v148, v204, v205
    v_cvt_pk_bf16_f32 v149, v206, v207
    v_mfma_f32_16x16x32_bf16 v[180:183], v[240:243], a[252:255], v[180:183]
    v_cvt_pk_bf16_f32 v154, v208, v209
    v_cvt_pk_bf16_f32 v155, v210, v211
    v_cvt_pk_bf16_f32 v144, v200, v201
    v_cvt_pk_bf16_f32 v145, v202, v203
    v_cvt_pk_bf16_f32 v146, v220, v221
    v_cvt_pk_bf16_f32 v147, v222, v223
    v_cvt_pk_bf16_f32 v150, v212, v213
    v_cvt_pk_bf16_f32 v151, v214, v215
    v_pk_mul_f32 v[168:169], v[168:169], s[52:53] op_sel_hi:[1,0]
    v_pk_mul_f32 v[170:171], v[170:171], s[52:53] op_sel_hi:[1,0]
    v_cvt_pk_bf16_f32 v128, v168, v169
    v_cvt_pk_bf16_f32 v129, v170, v171
    v_pk_mul_f32 v[172:173], v[172:173], s[52:53] op_sel_hi:[1,0]
    v_pk_mul_f32 v[174:175], v[174:175], s[52:53] op_sel_hi:[1,0]
    v_cvt_pk_bf16_f32 v130, v172, v173
    v_cvt_pk_bf16_f32 v131, v174, v175
    v_mfma_f32_16x16x16_bf16 v[224:227], v[144:145], v[128:129], v[88:91]
    v_mfma_f32_16x16x16_bf16 v[228:231], v[136:137], v[128:129], v[80:83]
    v_pk_mul_f32 v[176:177], v[176:177], s[52:53] op_sel_hi:[1,0]
    v_pk_mul_f32 v[178:179], v[178:179], s[52:53] op_sel_hi:[1,0]
    v_cvt_pk_bf16_f32 v132, v176, v177
    v_cvt_pk_bf16_f32 v133, v178, v179
    buffer_load_dwordx4 a[48:51], v20, s[40:43], s85 offen offset:2048 sc1
    v_mfma_f32_16x16x16_bf16 v[232:235], v[144:145], v[130:131], v[92:95]
    v_mfma_f32_16x16x16_bf16 v[236:239], v[138:139], v[130:131], v[80:83]
    v_pk_mul_f32 v[180:181], v[180:181], s[52:53] op_sel_hi:[1,0]
    v_pk_mul_f32 v[182:183], v[182:183], s[52:53] op_sel_hi:[1,0]
    v_cvt_pk_bf16_f32 v134, v180, v181
    v_cvt_pk_bf16_f32 v135, v182, v183
    v_mfma_f32_16x16x16_bf16 v[240:243], v[136:137], v[132:133], v[84:87]
    v_mfma_f32_16x16x16_bf16 v[244:247], v[140:141], v[132:133], v[80:83]
    v_cvt_pk_bf16_f32 v152, v220, v221
    v_cvt_pk_bf16_f32 v153, v222, v223
    v_mfma_f32_16x16x16_bf16 v[248:251], v[138:139], v[134:135], v[84:87]
    v_mfma_f32_16x16x16_bf16 v[252:255], v[142:143], v[134:135], v[80:83]
    s_mov_b64 exec, s[62:63]
    buffer_load_dwordx4 a[52:55], v21, s[40:43], s85 offen offset:3072 sc1
    buffer_load_dwordx4 a[56:59], v21, s[40:43], s85 offen offset:3584 sc1
    s_mov_b64 exec, -1
    v_cvt_pk_bf16_f32 v156, v216, v217
    v_cvt_pk_bf16_f32 v157, v218, v219
    v_exp_f32 v224, v224
    v_exp_f32 v225, v225
    v_exp_f32 v226, v226
    v_exp_f32 v227, v227
    v_cvt_pk_bf16_f32 v204, v224, v225
    v_exp_f32 v228, v228
    v_exp_f32 v229, v229
    v_cvt_pk_bf16_f32 v205, v226, v227
    v_exp_f32 v230, v230
    v_exp_f32 v231, v231
    buffer_load_dwordx4 a[60:63], v20, s[40:43], s85 offen offset:0 sc1
    v_cvt_pk_bf16_f32 v206, v228, v229
    v_exp_f32 v232, v232
    v_exp_f32 v233, v233
    v_cvt_pk_bf16_f32 v207, v230, v231
    v_exp_f32 v234, v234
    v_exp_f32 v235, v235
    v_cvt_pk_bf16_f32 v208, v232, v233
    v_mfma_f32_16x16x32_bf16 v[184:187], v[6:9], v[204:207], 0
    v_mfma_f32_16x16x32_bf16 v[168:171], v[146:149], v[204:207], 0
    v_exp_f32 v236, v236
    v_exp_f32 v237, v237
    v_cvt_pk_bf16_f32 v209, v234, v235
    s_mov_b64 exec, s[62:63]
    buffer_load_dwordx4 a[64:67], v21, s[40:43], s85 offen offset:1024 sc1
    buffer_load_dwordx4 a[68:71], v21, s[40:43], s85 offen offset:1536 sc1
    s_mov_b64 exec, -1
    v_exp_f32 v238, v238
    v_exp_f32 v239, v239
    v_cvt_pk_bf16_f32 v210, v236, v237
    v_exp_f32 v240, v240
    v_exp_f32 v241, v241
    v_cvt_pk_bf16_f32 v211, v238, v239
    v_exp_f32 v242, v242
    v_exp_f32 v243, v243
    v_cvt_pk_bf16_f32 v212, v240, v241
    v_mfma_f32_16x16x32_bf16 v[188:191], v[6:9], v[208:211], 0
    v_mfma_f32_16x16x32_bf16 v[172:175], v[152:155], v[208:211], 0
    v_exp_f32 v244, v244
    buffer_load_dwordx4 a[72:75], v20, s[40:43], s84 offen offset:2048 sc1
    v_exp_f32 v245, v245
    v_cvt_pk_bf16_f32 v213, v242, v243
    v_exp_f32 v246, v246
    v_exp_f32 v247, v247
    v_cvt_pk_bf16_f32 v214, v244, v245
    v_exp_f32 v248, v248
    v_exp_f32 v249, v249
    v_cvt_pk_bf16_f32 v215, v246, v247
    v_exp_f32 v250, v250
    v_exp_f32 v251, v251
    v_cvt_pk_bf16_f32 v216, v248, v249
    v_mfma_f32_16x16x32_bf16 v[192:195], v[6:9], v[212:215], 0
    s_mov_b64 exec, s[62:63]
    buffer_load_dwordx4 a[76:79], v21, s[40:43], s84 offen offset:3072 sc1
    buffer_load_dwordx4 a[80:83], v21, s[40:43], s84 offen offset:3584 sc1
    s_mov_b64 exec, -1
    v_mfma_f32_16x16x32_bf16 v[176:179], v[148:151], v[212:215], 0
    v_exp_f32 v252, v252
    v_exp_f32 v253, v253
    v_cvt_pk_bf16_f32 v217, v250, v251
    v_exp_f32 v254, v254
    v_exp_f32 v255, v255
    v_cvt_pk_bf16_f32 v218, v252, v253
    s_nop 0
    v_cvt_pk_bf16_f32 v219, v254, v255
    s_nop 1
    v_mfma_f32_16x16x32_bf16 v[196:199], v[6:9], v[216:219], 0
    v_mfma_f32_16x16x32_bf16 v[180:183], v[154:157], v[216:219], 0
    buffer_load_dwordx4 a[84:87], v20, s[40:43], s84 offen offset:0 sc1
    s_mov_b64 exec, s[62:63]
    buffer_load_dwordx4 a[88:91], v21, s[40:43], s84 offen offset:1024 sc1
    buffer_load_dwordx4 a[92:95], v21, s[40:43], s84 offen offset:1536 sc1
    s_mov_b64 exec, -1
    s_mov_b32 s72, 1736441856
    v_rcp_f32 v158, v184
    v_rcp_f32 v159, v188
    v_rcp_f32 v160, v192
    v_rcp_f32 v161, v196
    v_add_f32 v162, v184, v188
    v_add_f32 v163, v192, v196
    v_add_f32 v164, v158, v159
    v_add_f32 v165, v160, v161
    v_add_f32 v162, v162, v163
    v_add_f32 v164, v164, v165
    v_add_f32 v162, v162, v164
    v_cmp_nlt_f32 vcc, v162, s72
    s_nop 1
    s_cmp_lg_u64 vcc, 0
    s_cbranch_scc1 L_slowb
L_backb:
    v_mfma_f32_32x32x16_bf16 v[224:239], v[96:99], v[120:123], v[48:63]
    v_mul_f32 v184, v158, v38
    v_mul_f32 v188, v159, v39
    v_mul_f32 v192, v160, v40
    v_mul_f32 v196, v161, v41
    v_pk_mul_f32 v[168:169], v[168:169], v[184:185] op_sel_hi:[1,0]
    v_pk_mul_f32 v[170:171], v[170:171], v[184:185] op_sel_hi:[1,0]
    v_cvt_pk_bf16_f32 v128, v168, v169
    v_cvt_pk_bf16_f32 v129, v170, v171
    v_pk_mul_f32 v[172:173], v[172:173], v[188:189] op_sel_hi:[1,0]
    v_pk_mul_f32 v[174:175], v[174:175], v[188:189] op_sel_hi:[1,0]
    v_cvt_pk_bf16_f32 v130, v172, v173
    v_cvt_pk_bf16_f32 v131, v174, v175
    v_pk_mul_f32 v[176:177], v[176:177], v[192:193] op_sel_hi:[1,0]
    v_pk_mul_f32 v[178:179], v[178:179], v[192:193] op_sel_hi:[1,0]
    v_cvt_pk_bf16_f32 v132, v176, v177
    v_cvt_pk_bf16_f32 v133, v178, v179
    v_pk_mul_f32 v[180:181], v[180:181], v[196:197] op_sel_hi:[1,0]
    v_pk_mul_f32 v[182:183], v[182:183], v[196:197] op_sel_hi:[1,0]
    v_cvt_pk_bf16_f32 v134, v180, v181
    v_cvt_pk_bf16_f32 v135, v182, v183
    v_permlane16_swap_b32 v128, v130
    v_permlane16_swap_b32 v129, v131
    v_permlane16_swap_b32 v132, v134
    v_permlane16_swap_b32 v133, v135
    v_permlane32_swap_b32 v128, v130
    v_permlane32_swap_b32 v129, v131
    v_permlane32_swap_b32 v132, v134
    v_permlane32_swap_b32 v133, v135
    s_add_u32 s71, s99, 32768
    buffer_store_dwordx4 v[128:131], v20, s[40:43], s99 offen sc1
    buffer_store_dwordx4 v[132:135], v20, s[40:43], s71 offen sc1
    s_barrier
    v_mfma_f32_32x32x16_bf16 v[240:255], v[100:103], v[124:127], v[48:63]
    v_exp_f32 v224, v224
    v_exp_f32 v225, v225
    v_exp_f32 v226, v226
    v_exp_f32 v227, v227
    v_cvt_pk_bf16_f32 v204, v224, v225
    v_exp_f32 v228, v228
    v_exp_f32 v229, v229
    v_cvt_pk_bf16_f32 v205, v226, v227
    v_exp_f32 v230, v230
    v_exp_f32 v231, v231
    v_cvt_pk_bf16_f32 v206, v228, v229
    v_exp_f32 v232, v232
    v_exp_f32 v233, v233
    v_cvt_pk_bf16_f32 v207, v230, v231
    v_exp_f32 v234, v234
    v_exp_f32 v235, v235
    v_cvt_pk_bf16_f32 v208, v232, v233
    v_mfma_f32_32x32x16_bf16 v[136:151], v[104:107], v[204:207], 0
    s_bitcmp1_b32 s66, 0
    s_cselect_b64 s[28:29], s[32:33], s[36:37]
    s_cselect_b32 s71, 65536, 0
    s_add_u32 m0, s76, s71
    v_exp_f32 v236, v236
    v_exp_f32 v237, v237
    v_cvt_pk_bf16_f32 v209, v234, v235
    v_exp_f32 v238, v238
    v_exp_f32 v239, v239
    v_cvt_pk_bf16_f32 v210, v236, v237
    v_cvt_pk_bf16_f32 v211, v238, v239
    v_mfma_f32_32x32x16_bf16 v[224:239], v[96:99], v[124:127], 0
    v_exp_f32 v240, v240
    v_exp_f32 v241, v241
    v_exp_f32 v242, v242
    v_exp_f32 v243, v243
    v_cvt_pk_bf16_f32 v212, v240, v241
    v_exp_f32 v244, v244
    v_exp_f32 v245, v245
    v_cvt_pk_bf16_f32 v213, v242, v243
    v_mfma_f32_32x32x16_bf16 v[136:151], v[108:111], v[208:211], v[136:151]
    v_exp_f32 v246, v246
    v_exp_f32 v247, v247
    v_cvt_pk_bf16_f32 v214, v244, v245
    v_exp_f32 v248, v248
    v_exp_f32 v249, v249
    v_cvt_pk_bf16_f32 v215, v246, v247
    v_exp_f32 v250, v250
    v_exp_f32 v251, v251
    v_cvt_pk_bf16_f32 v216, v248, v249
    v_mfma_f32_32x32x16_bf16 v[152:167], v[112:115], v[212:215], 0
    v_exp_f32 v252, v252
    v_exp_f32 v253, v253
    v_cvt_pk_bf16_f32 v217, v250, v251
    v_exp_f32 v254, v254
    v_exp_f32 v255, v255
    v_cvt_pk_bf16_f32 v218, v252, v253
    v_cvt_pk_bf16_f32 v219, v254, v255
    s_waitcnt vmcnt(23)
    v_mfma_f32_32x32x16_bf16 v[240:255], a[0:3], v[120:123], 0
    v_exp_f32 v224, v224
    v_exp_f32 v225, v225
    v_exp_f32 v226, v226
    v_exp_f32 v227, v227
    v_cvt_pk_bf16_f32 v204, v224, v225
    v_exp_f32 v228, v228
    v_exp_f32 v229, v229
    v_cvt_pk_bf16_f32 v205, v226, v227
    v_mfma_f32_32x32x16_bf16 v[152:167], v[116:119], v[216:219], v[152:167]
    v_exp_f32 v230, v230
    v_exp_f32 v231, v231
    v_cvt_pk_bf16_f32 v206, v228, v229
    v_exp_f32 v232, v232
    v_exp_f32 v233, v233
    v_cvt_pk_bf16_f32 v207, v230, v231
    v_exp_f32 v234, v234
    v_exp_f32 v235, v235
    v_cvt_pk_bf16_f32 v208, v232, v233
    v_mfma_f32_32x32x16_bf16 v[152:167], v[104:107], v[204:207], v[152:167]
    v_exp_f32 v236, v236
    v_exp_f32 v237, v237
    v_cvt_pk_bf16_f32 v209, v234, v235
    v_exp_f32 v238, v238
    v_exp_f32 v239, v239
    v_cvt_pk_bf16_f32 v210, v236, v237
    v_cvt_pk_bf16_f32 v211, v238, v239
    v_mfma_f32_32x32x16_bf16 v[224:239], a[0:3], v[124:127], 0
    v_exp_f32 v240, v240
    v_exp_f32 v241, v241
    v_exp_f32 v242, v242
    v_exp_f32 v243, v243
    v_cvt_pk_bf16_f32 v212, v240, v241
    v_exp_f32 v244, v244
    v_exp_f32 v245, v245
    v_cvt_pk_bf16_f32 v213, v242, v243
    v_mfma_f32_32x32x16_bf16 v[152:167], v[108:111], v[208:211], v[152:167]
    v_exp_f32 v246, v246
    v_exp_f32 v247, v247
    v_cvt_pk_bf16_f32 v214, v244, v245
    v_exp_f32 v248, v248
    v_exp_f32 v249, v249
    v_cvt_pk_bf16_f32 v215, v246, v247
    v_exp_f32 v250, v250
    v_exp_f32 v251, v251
    v_cvt_pk_bf16_f32 v216, v248, v249
    v_mfma_f32_32x32x16_bf16 v[136:151], a[4:7], v[212:215], v[136:151]
    v_exp_f32 v252, v252
    v_exp_f32 v253, v253
    v_cvt_pk_bf16_f32 v217, v250, v251
    v_exp_f32 v254, v254
    v_exp_f32 v255, v255
    v_cvt_pk_bf16_f32 v218, v252, v253
    v_cvt_pk_bf16_f32 v219, v254, v255
    s_waitcnt vmcnt(20)
    v_mfma_f32_32x32x16_bf16 v[240:255], a[12:15], v[120:123], 0
    s_waitcnt vmcnt(0)
    s_barrier
    s_atomic_swap_x2 s[56:57], s[40:41], s70
    v_exp_f32 v224, v224
    v_exp_f32 v225, v225
    v_exp_f32 v226, v226
    v_exp_f32 v227, v227
    v_cvt_pk_bf16_f32 v204, v224, v225
    v_exp_f32 v228, v228
    v_exp_f32 v229, v229
    v_cvt_pk_bf16_f32 v205, v226, v227
    v_mfma_f32_32x32x16_bf16 v[136:151], a[8:11], v[216:219], v[136:151]
    v_exp_f32 v230, v230
    v_exp_f32 v231, v231
    v_cvt_pk_bf16_f32 v206, v228, v229
    v_exp_f32 v232, v232
    v_exp_f32 v233, v233
    v_cvt_pk_bf16_f32 v207, v230, v231
    v_exp_f32 v234, v234
    v_exp_f32 v235, v235
    v_cvt_pk_bf16_f32 v208, v232, v233
    v_mfma_f32_32x32x16_bf16 v[152:167], a[4:7], v[204:207], v[152:167]
    v_exp_f32 v236, v236
    v_exp_f32 v237, v237
    v_cvt_pk_bf16_f32 v209, v234, v235
    v_exp_f32 v238, v238
    v_exp_f32 v239, v239
    v_cvt_pk_bf16_f32 v210, v236, v237
    v_cvt_pk_bf16_f32 v211, v238, v239
    v_mfma_f32_32x32x16_bf16 v[224:239], a[12:15], v[124:127], 0
    buffer_load_dwordx4 v26, s[28:31], s80 offen offset:0 lds
    v_exp_f32 v240, v240
    v_exp_f32 v241, v241
    v_exp_f32 v242, v242
    v_exp_f32 v243, v243
    v_cvt_pk_bf16_f32 v212, v240, v241
    v_exp_f32 v244, v244
    v_exp_f32 v245, v245
    v_cvt_pk_bf16_f32 v213, v242, v243
    v_mfma_f32_32x32x16_bf16 v[152:167], a[8:11], v[208:211], v[152:167]
    buffer_load_dwordx4 v27, s[28:31], s80 offen offset:1024 lds
    v_exp_f32 v246, v246
    v_exp_f32 v247, v247
    v_cvt_pk_bf16_f32 v214, v244, v245
    v_exp_f32 v248, v248
    v_exp_f32 v249, v249
    v_cvt_pk_bf16_f32 v215, v246, v247
    v_exp_f32 v250, v250
    v_exp_f32 v251, v251
    v_cvt_pk_bf16_f32 v216, v248, v249
    v_mfma_f32_32x32x16_bf16 v[136:151], a[16:19], v[212:215], v[136:151]
    buffer_load_dwordx4 v28, s[28:31], s80 offen offset:2048 lds
    v_exp_f32 v252, v252
    v_exp_f32 v253, v253
    v_cvt_pk_bf16_f32 v217, v250, v251
    v_exp_f32 v254, v254
    v_exp_f32 v255, v255
    v_cvt_pk_bf16_f32 v218, v252, v253
    v_cvt_pk_bf16_f32 v219, v254, v255
    v_mfma_f32_32x32x16_bf16 v[240:255], a[24:27], v[120:123], 0
    buffer_load_dwordx4 v29, s[28:31], s80 offen offset:3072 lds
    s_bitcmp1_b32 s66, 0
    s_cselect_b64 s[28:29], s[36:37], s[32:33]
    s_cselect_b32 s71, 0, 65536
    s_add_u32 m0, s76, s71
    v_exp_f32 v224, v224
    v_exp_f32 v225, v225
    v_exp_f32 v226, v226
    v_exp_f32 v227, v227
    v_cvt_pk_bf16_f32 v204, v224, v225
    v_exp_f32 v228, v228
    v_exp_f32 v229, v229
    v_cvt_pk_bf16_f32 v205, v226, v227
    v_mfma_f32_32x32x16_bf16 v[136:151], a[20:23], v[216:219], v[136:151]
    v_exp_f32 v230, v230
    v_exp_f32 v231, v231
    v_cvt_pk_bf16_f32 v206, v228, v229
    v_exp_f32 v232, v232
    v_exp_f32 v233, v233
    v_cvt_pk_bf16_f32 v207, v230, v231
    v_exp_f32 v234, v234
    v_exp_f32 v235, v235
    v_cvt_pk_bf16_f32 v208, v232, v233
    v_mfma_f32_32x32x16_bf16 v[152:167], a[16:19], v[204:207], v[152:167]
    v_exp_f32 v236, v236
    v_exp_f32 v237, v237
    v_cvt_pk_bf16_f32 v209, v234, v235
    v_exp_f32 v238, v238
    v_exp_f32 v239, v239
    v_cvt_pk_bf16_f32 v210, v236, v237
    v_cvt_pk_bf16_f32 v211, v238, v239
    v_mfma_f32_32x32x16_bf16 v[224:239], a[24:27], v[124:127], 0
    buffer_load_dwordx4 v26, s[28:31], s80 offen offset:0 lds
    v_exp_f32 v240, v240
    v_exp_f32 v241, v241
    v_exp_f32 v242, v242
    v_exp_f32 v243, v243
    v_cvt_pk_bf16_f32 v212, v240, v241
    v_exp_f32 v244, v244
    v_exp_f32 v245, v245
    v_cvt_pk_bf16_f32 v213, v242, v243
    v_mfma_f32_32x32x16_bf16 v[152:167], a[20:23], v[208:211], v[152:167]
    v_exp_f32 v246, v246
    v_exp_f32 v247, v247
    v_cvt_pk_bf16_f32 v214, v244, v245
    v_exp_f32 v248, v248
    v_exp_f32 v249, v249
    v_cvt_pk_bf16_f32 v215, v246, v247
    v_exp_f32 v250, v250
    v_exp_f32 v251, v251
    v_cvt_pk_bf16_f32 v216, v248, v249
    v_mfma_f32_32x32x16_bf16 v[136:151], a[28:31], v[212:215], v[136:151]
    v_exp_f32 v252, v252
    v_exp_f32 v253, v253
    v_cvt_pk_bf16_f32 v217, v250, v251
    v_exp_f32 v254, v254
    v_exp_f32 v255, v255
    v_cvt_pk_bf16_f32 v218, v252, v253
    v_cvt_pk_bf16_f32 v219, v254, v255
    v_mfma_f32_32x32x16_bf16 v[240:255], a[36:39], v[120:123], 0
    buffer_load_dwordx4 v27, s[28:31], s80 offen offset:1024 lds
    v_exp_f32 v224, v224
    v_exp_f32 v225, v225
    v_exp_f32 v226, v226
    v_exp_f32 v227, v227
    v_cvt_pk_bf16_f32 v204, v224, v225
    v_exp_f32 v228, v228
    v_exp_f32 v229, v229
    v_cvt_pk_bf16_f32 v205, v226, v227
    v_mfma_f32_32x32x16_bf16 v[136:151], a[32:35], v[216:219], v[136:151]
    v_exp_f32 v230, v230
    v_exp_f32 v231, v231
    v_cvt_pk_bf16_f32 v206, v228, v229
    v_exp_f32 v232, v232
    v_exp_f32 v233, v233
    v_cvt_pk_bf16_f32 v207, v230, v231
    v_exp_f32 v234, v234
    v_exp_f32 v235, v235
    v_cvt_pk_bf16_f32 v208, v232, v233
    v_mfma_f32_32x32x16_bf16 v[152:167], a[28:31], v[204:207], v[152:167]
    v_exp_f32 v236, v236
    v_exp_f32 v237, v237
    v_cvt_pk_bf16_f32 v209, v234, v235
    v_exp_f32 v238, v238
    v_exp_f32 v239, v239
    v_cvt_pk_bf16_f32 v210, v236, v237
    v_cvt_pk_bf16_f32 v211, v238, v239
    v_mfma_f32_32x32x16_bf16 v[224:239], a[36:39], v[124:127], 0
    buffer_load_dwordx4 v28, s[28:31], s80 offen offset:2048 lds
    v_exp_f32 v240, v240
    v_exp_f32 v241, v241
    v_exp_f32 v242, v242
    v_exp_f32 v243, v243
    v_cvt_pk_bf16_f32 v212, v240, v241
    v_exp_f32 v244, v244
    v_exp_f32 v245, v245
    v_cvt_pk_bf16_f32 v213, v242, v243
    v_mfma_f32_32x32x16_bf16 v[152:167], a[32:35], v[208:211], v[152:167]
    v_exp_f32 v246, v246
    v_exp_f32 v247, v247
    v_cvt_pk_bf16_f32 v214, v244, v245
    v_exp_f32 v248, v248
    v_exp_f32 v249, v249
    v_cvt_pk_bf16_f32 v215, v246, v247
    v_exp_f32 v250, v250
    v_exp_f32 v251, v251
    v_cvt_pk_bf16_f32 v216, v248, v249
    v_mfma_f32_32x32x16_bf16 v[136:151], a[40:43], v[212:215], v[136:151]
    v_exp_f32 v252, v252
    v_exp_f32 v253, v253
    v_cvt_pk_bf16_f32 v217, v250, v251
    v_exp_f32 v254, v254
    v_exp_f32 v255, v255
    v_cvt_pk_bf16_f32 v218, v252, v253
    v_cvt_pk_bf16_f32 v219, v254, v255
    v_mfma_f32_32x32x16_bf16 v[240:255], a[48:51], v[120:123], 0
    s_cmp_lg_u32 s67, 0
    s_cbranch_scc1 L_pb0
    s_buffer_load_dwordx16 s[4:19], s[40:43], s74 glc
L_pb0:
    buffer_load_dwordx4 v29, s[28:31], s80 offen offset:3072 lds
    s_add_u32 m0, s77, 0
    v_exp_f32 v224, v224
    v_exp_f32 v225, v225
    v_exp_f32 v226, v226
    v_exp_f32 v227, v227
    v_cvt_pk_bf16_f32 v204, v224, v225
    v_exp_f32 v228, v228
    v_exp_f32 v229, v229
    v_cvt_pk_bf16_f32 v205, v226, v227
    v_mfma_f32_32x32x16_bf16 v[136:151], a[44:47], v[216:219], v[136:151]
    buffer_load_dwordx4 v26, s[36:39], s81 offen offset:0 lds
    v_exp_f32 v230, v230
    v_exp_f32 v231, v231
    v_cvt_pk_bf16_f32 v206, v228, v229
    v_exp_f32 v232, v232
    v_exp_f32 v233, v233
    v_cvt_pk_bf16_f32 v207, v230, v231
    v_exp_f32 v234, v234
    v_exp_f32 v235, v235
    v_cvt_pk_bf16_f32 v208, v232, v233
    v_mfma_f32_32x32x16_bf16 v[152:167], a[40:43], v[204:207], v[152:167]
    buffer_load_dwordx4 v27, s[36:39], s81 offen offset:1024 lds
    v_exp_f32 v236, v236
    v_exp_f32 v237, v237
    v_cvt_pk_bf16_f32 v209, v234, v235
    v_exp_f32 v238, v238
    v_exp_f32 v239, v239
    v_cvt_pk_bf16_f32 v210, v236, v237
    v_cvt_pk_bf16_f32 v211, v238, v239
    v_mfma_f32_32x32x16_bf16 v[224:239], a[48:51], v[124:127], 0
    buffer_load_dwordx4 v28, s[36:39], s81 offen offset:2048 lds
    v_exp_f32 v240, v240
    v_exp_f32 v241, v241
    v_exp_f32 v242, v242
    v_exp_f32 v243, v243
    v_cvt_pk_bf16_f32 v212, v240, v241
    v_exp_f32 v244, v244
    v_exp_f32 v245, v245
    v_cvt_pk_bf16_f32 v213, v242, v243
    v_mfma_f32_32x32x16_bf16 v[152:167], a[44:47], v[208:211], v[152:167]
    buffer_load_dwordx4 v29, s[36:39], s81 offen offset:3072 lds
    s_add_u32 m0, s78, 0
    v_exp_f32 v246, v246
    v_exp_f32 v247, v247
    v_cvt_pk_bf16_f32 v214, v244, v245
    v_exp_f32 v248, v248
    v_exp_f32 v249, v249
    v_cvt_pk_bf16_f32 v215, v246, v247
    v_exp_f32 v250, v250
    v_exp_f32 v251, v251
    v_cvt_pk_bf16_f32 v216, v248, v249
    v_mfma_f32_32x32x16_bf16 v[136:151], a[52:55], v[212:215], v[136:151]
    buffer_load_dwordx4 v26, s[36:39], s82 offen offset:0 lds
    v_exp_f32 v252, v252
    v_exp_f32 v253, v253
    v_cvt_pk_bf16_f32 v217, v250, v251
    v_exp_f32 v254, v254
    v_exp_f32 v255, v255
    v_cvt_pk_bf16_f32 v218, v252, v253
    v_cvt_pk_bf16_f32 v219, v254, v255
    v_mfma_f32_32x32x16_bf16 v[240:255], a[60:63], v[120:123], 0
    v_exp_f32 v224, v224
    v_exp_f32 v225, v225
    v_exp_f32 v226, v226
    v_exp_f32 v227, v227
    v_cvt_pk_bf16_f32 v204, v224, v225
    v_exp_f32 v228, v228
    v_exp_f32 v229, v229
    v_cvt_pk_bf16_f32 v205, v226, v227
    v_mfma_f32_32x32x16_bf16 v[136:151], a[56:59], v[216:219], v[136:151]
    v_exp_f32 v230, v230
    v_exp_f32 v231, v231
    v_cvt_pk_bf16_f32 v206, v228, v229
    v_exp_f32 v232, v232
    v_exp_f32 v233, v233
    v_cvt_pk_bf16_f32 v207, v230, v231
    v_exp_f32 v234, v234
    v_exp_f32 v235, v235
    v_cvt_pk_bf16_f32 v208, v232, v233
    v_mfma_f32_32x32x16_bf16 v[152:167], a[52:55], v[204:207], v[152:167]
    v_exp_f32 v236, v236
    v_exp_f32 v237, v237
    v_cvt_pk_bf16_f32 v209, v234, v235
    v_exp_f32 v238, v238
    v_exp_f32 v239, v239
    v_cvt_pk_bf16_f32 v210, v236, v237
    v_cvt_pk_bf16_f32 v211, v238, v239
    v_mfma_f32_32x32x16_bf16 v[224:239], a[60:63], v[124:127], 0
    buffer_load_dwordx4 v27, s[36:39], s82 offen offset:1024 lds
    v_exp_f32 v240, v240
    v_exp_f32 v241, v241
    v_exp_f32 v242, v242
    v_exp_f32 v243, v243
    v_cvt_pk_bf16_f32 v212, v240, v241
    v_exp_f32 v244, v244
    v_exp_f32 v245, v245
    v_cvt_pk_bf16_f32 v213, v242, v243
    v_mfma_f32_32x32x16_bf16 v[152:167], a[56:59], v[208:211], v[152:167]
    buffer_load_dwordx4 v28, s[36:39], s82 offen offset:2048 lds
    v_exp_f32 v246, v246
    v_exp_f32 v247, v247
    v_cvt_pk_bf16_f32 v214, v244, v245
    v_exp_f32 v248, v248
    v_exp_f32 v249, v249
    v_cvt_pk_bf16_f32 v215, v246, v247
    v_exp_f32 v250, v250
    v_exp_f32 v251, v251
    v_cvt_pk_bf16_f32 v216, v248, v249
    v_mfma_f32_32x32x16_bf16 v[136:151], a[64:67], v[212:215], v[136:151]
    buffer_load_dwordx4 v29, s[36:39], s82 offen offset:3072 lds
    s_add_u32 m0, s79, 0
    v_exp_f32 v252, v252
    v_exp_f32 v253, v253
    v_cvt_pk_bf16_f32 v217, v250, v251
    v_exp_f32 v254, v254
    v_exp_f32 v255, v255
    v_cvt_pk_bf16_f32 v218, v252, v253
    v_cvt_pk_bf16_f32 v219, v254, v255
    v_mfma_f32_32x32x16_bf16 v[240:255], a[72:75], v[120:123], 0
    s_cmp_lg_u32 s67, 0
    s_cbranch_scc1 L_pbok
    s_waitcnt lgkmcnt(0)
L_pb:
    s_xor_b64 s[4:5], s[4:5], s[48:49]
    s_xor_b64 s[6:7], s[6:7], s[48:49]
    s_xor_b64 s[8:9], s[8:9], s[48:49]
    s_xor_b64 s[10:11], s[10:11], s[48:49]
    s_xor_b64 s[12:13], s[12:13], s[48:49]
    s_xor_b64 s[14:15], s[14:15], s[48:49]
    s_xor_b64 s[16:17], s[16:17], s[48:49]
    s_xor_b64 s[18:19], s[18:19], s[48:49]
    s_or_b64 s[4:5], s[4:5], s[6:7]
    s_or_b64 s[8:9], s[8:9], s[10:11]
    s_or_b64 s[12:13], s[12:13], s[14:15]
    s_or_b64 s[16:17], s[16:17], s[18:19]
    s_or_b64 s[4:5], s[4:5], s[8:9]
    s_or_b64 s[12:13], s[12:13], s[16:17]
    s_or_b64 s[4:5], s[4:5], s[12:13]
    s_cbranch_scc1 L_pbr
L_pbok:
    s_barrier
    buffer_load_dwordx4 v26, s[36:39], s83 offen offset:0 lds
    v_exp_f32 v224, v224
    v_exp_f32 v225, v225
    v_exp_f32 v226, v226
    v_exp_f32 v227, v227
    v_cvt_pk_bf16_f32 v204, v224, v225
    v_exp_f32 v228, v228
    v_exp_f32 v229, v229
    v_cvt_pk_bf16_f32 v205, v226, v227
    v_mfma_f32_32x32x16_bf16 v[136:151], a[68:71], v[216:219], v[136:151]
    buffer_load_dwordx4 v27, s[36:39], s83 offen offset:1024 lds
    v_exp_f32 v230, v230
    v_exp_f32 v231, v231
    v_cvt_pk_bf16_f32 v206, v228, v229
    v_exp_f32 v232, v232
    v_exp_f32 v233, v233
    v_cvt_pk_bf16_f32 v207, v230, v231
    v_exp_f32 v234, v234
    v_exp_f32 v235, v235
    v_cvt_pk_bf16_f32 v208, v232, v233
    v_mfma_f32_32x32x16_bf16 v[152:167], a[64:67], v[204:207], v[152:167]
    buffer_load_dwordx4 v28, s[36:39], s83 offen offset:2048 lds
    v_exp_f32 v236, v236
    v_exp_f32 v237, v237
    v_cvt_pk_bf16_f32 v209, v234, v235
    v_exp_f32 v238, v238
    v_exp_f32 v239, v239
    v_cvt_pk_bf16_f32 v210, v236, v237
    v_cvt_pk_bf16_f32 v211, v238, v239
    v_mfma_f32_32x32x16_bf16 v[224:239], a[72:75], v[124:127], v[64:79]
    buffer_load_dwordx4 v29, s[36:39], s83 offen offset:3072 lds
    v_exp_f32 v240, v240
    v_exp_f32 v241, v241
    v_exp_f32 v242, v242
    v_exp_f32 v243, v243
    v_cvt_pk_bf16_f32 v212, v240, v241
    v_exp_f32 v244, v244
    v_exp_f32 v245, v245
    v_cvt_pk_bf16_f32 v213, v242, v243
    v_mfma_f32_32x32x16_bf16 v[152:167], a[68:71], v[208:211], v[152:167]
    buffer_load_dwordx4 a[96:99], v20, s[40:43], s24 offen offset:0 sc1
    v_exp_f32 v246, v246
    v_exp_f32 v247, v247
    v_cvt_pk_bf16_f32 v214, v244, v245
    v_exp_f32 v248, v248
    v_exp_f32 v249, v249
    v_cvt_pk_bf16_f32 v215, v246, v247
    v_exp_f32 v250, v250
    v_exp_f32 v251, v251
    v_cvt_pk_bf16_f32 v216, v248, v249
    v_mfma_f32_32x32x16_bf16 v[136:151], a[76:79], v[212:215], v[136:151]
    buffer_load_dwordx4 a[100:103], v20, s[40:43], s24 offen offset:1024 sc1
    v_exp_f32 v252, v252
    v_exp_f32 v253, v253
    v_cvt_pk_bf16_f32 v217, v250, v251
    v_exp_f32 v254, v254
    v_exp_f32 v255, v255
    v_cvt_pk_bf16_f32 v218, v252, v253
    v_cvt_pk_bf16_f32 v219, v254, v255
    v_mfma_f32_32x32x16_bf16 v[240:255], a[84:87], v[120:123], v[64:79]
    buffer_load_dwordx4 a[104:107], v20, s[40:43], s24 offen offset:2048 sc1
    v_exp_f32 v224, v224
    v_exp_f32 v225, v225
    v_exp_f32 v226, v226
    v_exp_f32 v227, v227
    v_cvt_pk_bf16_f32 v204, v224, v225
    v_exp_f32 v228, v228
    v_exp_f32 v229, v229
    v_cvt_pk_bf16_f32 v205, v226, v227
    v_mfma_f32_32x32x16_bf16 v[136:151], a[80:83], v[216:219], v[136:151]
    buffer_load_dwordx4 a[108:111], v20, s[40:43], s24 offen offset:3072 sc1
    v_exp_f32 v230, v230
    v_exp_f32 v231, v231
    v_cvt_pk_bf16_f32 v206, v228, v229
    v_exp_f32 v232, v232
    v_exp_f32 v233, v233
    v_cvt_pk_bf16_f32 v207, v230, v231
    v_exp_f32 v234, v234
    v_exp_f32 v235, v235
    v_cvt_pk_bf16_f32 v208, v232, v233
    v_mfma_f32_32x32x16_bf16 v[152:167], a[76:79], v[204:207], v[152:167]
    buffer_load_dwordx4 a[112:115], v20, s[40:43], s25 offen offset:0 sc1
    v_exp_f32 v236, v236
    v_exp_f32 v237, v237
    v_cvt_pk_bf16_f32 v209, v234, v235
    v_exp_f32 v238, v238
    v_exp_f32 v239, v239
    v_cvt_pk_bf16_f32 v210, v236, v237
    v_cvt_pk_bf16_f32 v211, v238, v239
    v_exp_f32 v240, v240
    v_exp_f32 v241, v241
    v_exp_f32 v242, v242
    v_exp_f32 v243, v243
    v_cvt_pk_bf16_f32 v212, v240, v241
    v_exp_f32 v244, v244
    v_exp_f32 v245, v245
    v_cvt_pk_bf16_f32 v213, v242, v243
    v_mfma_f32_32x32x16_bf16 v[152:167], a[80:83], v[208:211], v[152:167]
    buffer_load_dwordx4 a[116:119], v20, s[40:43], s25 offen offset:1024 sc1
    v_exp_f32 v246, v246
    v_exp_f32 v247, v247
    v_cvt_pk_bf16_f32 v214, v244, v245
    buffer_load_dwordx4 a[120:123], v20, s[40:43], s25 offen offset:2048 sc1
    v_exp_f32 v248, v248
    v_exp_f32 v249, v249
    v_cvt_pk_bf16_f32 v215, v246, v247
    v_exp_f32 v250, v250
    v_exp_f32 v251, v251
    v_cvt_pk_bf16_f32 v216, v248, v249
    v_mfma_f32_32x32x16_bf16 v[136:151], a[88:91], v[212:215], v[136:151]
    buffer_load_dwordx4 a[124:127], v20, s[40:43], s25 offen offset:3072 sc1
    v_exp_f32 v252, v252
    v_exp_f32 v253, v253
    v_cvt_pk_bf16_f32 v217, v250, v251
    v_exp_f32 v254, v254
    v_exp_f32 v255, v255
    v_cvt_pk_bf16_f32 v218, v252, v253
    v_cvt_pk_bf16_f32 v219, v254, v255
    s_nop 1
    v_mfma_f32_32x32x16_bf16 v[136:151], a[92:95], v[216:219], v[136:151]
    s_mov_b32 s72, 1736441856
    v_rcp_f32 v161, v160
    s_nop 0
    v_add_f32 v162, v160, v161
    v_mul_f32 v164, v161, v43
    v_pk_mul_f32 v[152:153], v[152:153], v[164:165] op_sel_hi:[1,0]
    v_pk_mul_f32 v[154:155], v[154:155], v[164:165] op_sel_hi:[1,0]
    v_pk_mul_f32 v[156:157], v[156:157], v[164:165] op_sel_hi:[1,0]
    v_pk_mul_f32 v[158:159], v[158:159], v[164:165] op_sel_hi:[1,0]
    v_cvt_pk_bf16_f32 v208, v152, v153
    v_cvt_pk_bf16_f32 v209, v154, v155
    v_cvt_pk_bf16_f32 v210, v156, v157
    v_cvt_pk_bf16_f32 v211, v158, v159
    v_rcp_f32 v145, v144
    v_add_f32 v162, v162, v144
    v_add_f32 v162, v162, v145
    v_mul_f32 v148, v145, v42
    v_cmp_nlt_f32 vcc, v162, s72
    v_pk_mul_f32 v[136:137], v[136:137], v[148:149] op_sel_hi:[1,0]
    v_pk_mul_f32 v[138:139], v[138:139], v[148:149] op_sel_hi:[1,0]
    v_pk_mul_f32 v[140:141], v[140:141], v[148:149] op_sel_hi:[1,0]
    v_pk_mul_f32 v[142:143], v[142:143], v[148:149] op_sel_hi:[1,0]
    v_cvt_pk_bf16_f32 v204, v136, v137
    v_cvt_pk_bf16_f32 v205, v138, v139
    v_cvt_pk_bf16_f32 v206, v140, v141
    v_cvt_pk_bf16_f32 v207, v142, v143
    s_cmp_lg_u64 vcc, 0
    s_cbranch_scc1 L_slowa
L_backa:
    s_add_u32 s71, s98, 32768
    buffer_store_dwordx4 v[208:211], v20, s[40:43], s71 offen sc1
    buffer_store_dwordx4 v[204:207], v20, s[40:43], s98 offen sc1
    buffer_load_dwordx4 a[128:131], v20, s[40:43], s26 offen offset:0 sc1
    s_waitcnt vmcnt(1)
    s_barrier
    s_atomic_swap_x2 s[56:57], s[40:41], s68
    buffer_load_dwordx4 a[132:135], v20, s[40:43], s26 offen offset:1024 sc1
    buffer_load_dwordx4 a[136:139], v20, s[40:43], s26 offen offset:2048 sc1
    buffer_load_dwordx4 a[140:143], v20, s[40:43], s26 offen offset:3072 sc1
    buffer_load_dwordx4 a[144:147], v20, s[40:43], s27 offen offset:0 sc1
    buffer_load_dwordx4 a[148:151], v20, s[40:43], s27 offen offset:1024 sc1
    buffer_load_dwordx4 a[152:155], v20, s[40:43], s27 offen offset:2048 sc1
    buffer_load_dwordx4 a[156:159], v20, s[40:43], s27 offen offset:3072 sc1
    ds_read_b64_tr_b16 v[160:161], v30 offset:0
    ds_read_b64_tr_b16 v[162:163], v30 offset:256
    ds_read_b64_tr_b16 v[164:165], v31 offset:0
    ds_read_b64_tr_b16 v[166:167], v31 offset:256
    ds_read_b64_tr_b16 v[168:169], v30 offset:512
    ds_read_b64_tr_b16 v[170:171], v30 offset:768
    ds_read_b64_tr_b16 v[172:173], v31 offset:512
    ds_read_b64_tr_b16 v[174:175], v31 offset:768
    s_waitcnt lgkmcnt(6)
    v_mfma_f32_32x32x16_bf16 v[128:143], v[160:163], a[96:99], 0
    s_add_u32 m0, s77, 65536
    s_nop 0
    buffer_load_dwordx4 v26, s[32:35], s81 offen offset:0 lds
    ds_read_b64_tr_b16 v[176:177], v30 offset:4096
    ds_read_b64_tr_b16 v[178:179], v30 offset:4352
    s_waitcnt lgkmcnt(6)
    v_mfma_f32_32x32x16_bf16 v[144:159], v[164:167], a[96:99], 0
    ds_read_b64_tr_b16 v[180:181], v31 offset:4096
    ds_read_b64_tr_b16 v[182:183], v31 offset:4352
    s_waitcnt lgkmcnt(6)
    v_mfma_f32_32x32x16_bf16 v[128:143], v[168:171], a[100:103], v[128:143]
    buffer_load_dwordx4 v27, s[32:35], s81 offen offset:1024 lds
    ds_read_b64_tr_b16 v[160:161], v30 offset:4608
    ds_read_b64_tr_b16 v[162:163], v30 offset:4864
    s_waitcnt lgkmcnt(6)
    v_mfma_f32_32x32x16_bf16 v[144:159], v[172:175], a[100:103], v[144:159]
    ds_read_b64_tr_b16 v[164:165], v31 offset:4608
    ds_read_b64_tr_b16 v[166:167], v31 offset:4864
    s_waitcnt lgkmcnt(6)
    v_mfma_f32_32x32x16_bf16 v[128:143], v[176:179], a[104:107], v[128:143]
    buffer_load_dwordx4 v28, s[32:35], s81 offen offset:2048 lds
    ds_read_b64_tr_b16 v[168:169], v30 offset:16384
    ds_read_b64_tr_b16 v[170:171], v30 offset:16640
    s_waitcnt lgkmcnt(6)
    v_mfma_f32_32x32x16_bf16 v[144:159], v[180:183], a[104:107], v[144:159]
    ds_read_b64_tr_b16 v[172:173], v31 offset:16384
    ds_read_b64_tr_b16 v[174:175], v31 offset:16640
    s_waitcnt lgkmcnt(6)
    v_mfma_f32_32x32x16_bf16 v[128:143], v[160:163], a[108:111], v[128:143]
    buffer_load_dwordx4 v29, s[32:35], s81 offen offset:3072 lds
    ds_read_b64_tr_b16 v[176:177], v30 offset:16896
    ds_read_b64_tr_b16 v[178:179], v30 offset:17152
    s_waitcnt lgkmcnt(6)
    v_mfma_f32_32x32x16_bf16 v[144:159], v[164:167], a[108:111], v[144:159]
    ds_read_b64_tr_b16 v[180:181], v31 offset:16896
    ds_read_b64_tr_b16 v[182:183], v31 offset:17152
    s_waitcnt lgkmcnt(6)
    v_mfma_f32_32x32x16_bf16 v[128:143], v[168:171], a[112:115], v[128:143]
    s_add_u32 m0, s78, 65536
    s_nop 0
    buffer_load_dwordx4 v26, s[32:35], s82 offen offset:0 lds
    ds_read_b64_tr_b16 v[160:161], v30 offset:20480
    ds_read_b64_tr_b16 v[162:163], v30 offset:20736
    s_waitcnt lgkmcnt(6)
    v_mfma_f32_32x32x16_bf16 v[144:159], v[172:175], a[112:115], v[144:159]
    ds_read_b64_tr_b16 v[164:165], v31 offset:20480
    ds_read_b64_tr_b16 v[166:167], v31 offset:20736
    s_waitcnt lgkmcnt(6)
    v_mfma_f32_32x32x16_bf16 v[128:143], v[176:179], a[116:119], v[128:143]
    buffer_load_dwordx4 v27, s[32:35], s82 offen offset:1024 lds
    ds_read_b64_tr_b16 v[168:169], v30 offset:20992
    ds_read_b64_tr_b16 v[170:171], v30 offset:21248
    s_waitcnt lgkmcnt(6)
    v_mfma_f32_32x32x16_bf16 v[144:159], v[180:183], a[116:119], v[144:159]
    ds_read_b64_tr_b16 v[172:173], v31 offset:20992
    ds_read_b64_tr_b16 v[174:175], v31 offset:21248
    s_cmp_lg_u32 s67, 0
    s_cbranch_scc1 L_pa0
    s_buffer_load_dwordx16 s[4:19], s[40:43], s73 glc
L_pa0:
    s_waitcnt lgkmcnt(6)
    v_mfma_f32_32x32x16_bf16 v[128:143], v[160:163], a[120:123], v[128:143]
    buffer_load_dwordx4 v28, s[32:35], s82 offen offset:2048 lds
    ds_read_b64_tr_b16 v[176:177], v30 offset:32768
    ds_read_b64_tr_b16 v[178:179], v30 offset:33024
    s_waitcnt lgkmcnt(6)
    v_mfma_f32_32x32x16_bf16 v[144:159], v[164:167], a[120:123], v[144:159]
    ds_read_b64_tr_b16 v[180:181], v31 offset:32768
    ds_read_b64_tr_b16 v[182:183], v31 offset:33024
    s_waitcnt lgkmcnt(6)
    v_mfma_f32_32x32x16_bf16 v[128:143], v[168:171], a[124:127], v[128:143]
    buffer_load_dwordx4 v29, s[32:35], s82 offen offset:3072 lds
    ds_read_b64_tr_b16 v[160:161], v30 offset:33280
    ds_read_b64_tr_b16 v[162:163], v30 offset:33536
    s_waitcnt lgkmcnt(6)
    v_mfma_f32_32x32x16_bf16 v[144:159], v[172:175], a[124:127], v[144:159]
    ds_read_b64_tr_b16 v[164:165], v31 offset:33280
    ds_read_b64_tr_b16 v[166:167], v31 offset:33536
    s_waitcnt vmcnt(12)
    s_waitcnt lgkmcnt(6)
    v_mfma_f32_32x32x16_bf16 v[128:143], v[176:179], a[128:131], v[128:143]
    s_add_u32 m0, s79, 65536
    s_nop 0
    buffer_load_dwordx4 v26, s[32:35], s83 offen offset:0 lds
    ds_read_b64_tr_b16 v[168:169], v30 offset:36864
    ds_read_b64_tr_b16 v[170:171], v30 offset:37120
    s_waitcnt lgkmcnt(6)
    v_mfma_f32_32x32x16_bf16 v[144:159], v[180:183], a[128:131], v[144:159]
    ds_read_b64_tr_b16 v[172:173], v31 offset:36864
    ds_read_b64_tr_b16 v[174:175], v31 offset:37120
    s_waitcnt lgkmcnt(6)
    v_mfma_f32_32x32x16_bf16 v[128:143], v[160:163], a[132:135], v[128:143]
    buffer_load_dwordx4 v27, s[32:35], s83 offen offset:1024 lds
    ds_read_b64_tr_b16 v[176:177], v30 offset:37376
    ds_read_b64_tr_b16 v[178:179], v30 offset:37632
    s_waitcnt lgkmcnt(6)
    v_mfma_f32_32x32x16_bf16 v[144:159], v[164:167], a[132:135], v[144:159]
    ds_read_b64_tr_b16 v[180:181], v31 offset:37376
    ds_read_b64_tr_b16 v[182:183], v31 offset:37632
    buffer_load_dwordx4 v28, s[32:35], s83 offen offset:2048 lds
    buffer_load_dwordx4 v29, s[32:35], s83 offen offset:3072 lds
    s_waitcnt lgkmcnt(0)
    s_cmp_lg_u32 s67, 0
    s_cbranch_scc1 L_paok
    s_waitcnt lgkmcnt(0)
L_pa:
    s_xor_b64 s[4:5], s[4:5], s[48:49]
    s_xor_b64 s[6:7], s[6:7], s[48:49]
    s_xor_b64 s[8:9], s[8:9], s[48:49]
    s_xor_b64 s[10:11], s[10:11], s[48:49]
    s_xor_b64 s[12:13], s[12:13], s[48:49]
    s_xor_b64 s[14:15], s[14:15], s[48:49]
    s_xor_b64 s[16:17], s[16:17], s[48:49]
    s_xor_b64 s[18:19], s[18:19], s[48:49]
    s_or_b64 s[4:5], s[4:5], s[6:7]
    s_or_b64 s[8:9], s[8:9], s[10:11]
    s_or_b64 s[12:13], s[12:13], s[14:15]
    s_or_b64 s[16:17], s[16:17], s[18:19]
    s_or_b64 s[4:5], s[4:5], s[8:9]
    s_or_b64 s[12:13], s[12:13], s[16:17]
    s_or_b64 s[4:5], s[4:5], s[12:13]
    s_cbranch_scc1 L_par
L_paok:
    s_barrier
    buffer_load_dwordx4 a[160:163], v20, s[40:43], s20 offen offset:0 sc1
    buffer_load_dwordx4 a[164:167], v20, s[40:43], s20 offen offset:1024 sc1
    buffer_load_dwordx4 a[168:171], v20, s[40:43], s20 offen offset:2048 sc1
    buffer_load_dwordx4 a[172:175], v20, s[40:43], s20 offen offset:3072 sc1
    v_mfma_f32_32x32x16_bf16 v[128:143], v[168:171], a[136:139], v[128:143]
    buffer_load_dwordx4 a[176:179], v20, s[40:43], s21 offen offset:0 sc1
    ds_read_b64_tr_b16 v[160:161], v30 offset:49152
    ds_read_b64_tr_b16 v[162:163], v30 offset:49408
    v_mfma_f32_32x32x16_bf16 v[144:159], v[172:175], a[136:139], v[144:159]
    ds_read_b64_tr_b16 v[164:165], v31 offset:49152
    ds_read_b64_tr_b16 v[166:167], v31 offset:49408
    v_mfma_f32_32x32x16_bf16 v[128:143], v[176:179], a[140:143], v[128:143]
    buffer_load_dwordx4 a[180:183], v20, s[40:43], s21 offen offset:1024 sc1
    ds_read_b64_tr_b16 v[168:169], v30 offset:49664
    ds_read_b64_tr_b16 v[170:171], v30 offset:49920
    v_mfma_f32_32x32x16_bf16 v[144:159], v[180:183], a[140:143], v[144:159]
    ds_read_b64_tr_b16 v[172:173], v31 offset:49664
    ds_read_b64_tr_b16 v[174:175], v31 offset:49920
    s_waitcnt vmcnt(18)
    s_waitcnt lgkmcnt(6)
    v_mfma_f32_32x32x16_bf16 v[128:143], v[160:163], a[144:147], v[128:143]
    buffer_load_dwordx4 a[184:187], v20, s[40:43], s21 offen offset:2048 sc1
    ds_read_b64_tr_b16 v[176:177], v30 offset:53248
    ds_read_b64_tr_b16 v[178:179], v30 offset:53504
    s_waitcnt lgkmcnt(6)
    v_mfma_f32_32x32x16_bf16 v[144:159], v[164:167], a[144:147], v[144:159]
    ds_read_b64_tr_b16 v[180:181], v31 offset:53248
    ds_read_b64_tr_b16 v[182:183], v31 offset:53504
    s_waitcnt lgkmcnt(6)
    v_mfma_f32_32x32x16_bf16 v[128:143], v[168:171], a[148:151], v[128:143]
    buffer_load_dwordx4 a[188:191], v20, s[40:43], s21 offen offset:3072 sc1
    ds_read_b64_tr_b16 v[160:161], v30 offset:53760
    ds_read_b64_tr_b16 v[162:163], v30 offset:54016
    s_waitcnt lgkmcnt(6)
    v_mfma_f32_32x32x16_bf16 v[144:159], v[172:175], a[148:151], v[144:159]
    ds_read_b64_tr_b16 v[164:165], v31 offset:53760
    ds_read_b64_tr_b16 v[166:167], v31 offset:54016
    s_waitcnt vmcnt(8)
    s_barrier
    v_add_u32 v30, 65536, v30
    v_add_u32 v31, 65536, v31
    s_waitcnt lgkmcnt(6)
    v_mfma_f32_32x32x16_bf16 v[128:143], v[176:179], a[152:155], v[128:143]
    buffer_load_dwordx4 a[192:195], v20, s[40:43], s22 offen offset:0 sc1
    ds_read_b64_tr_b16 v[168:169], v30 offset:0
    ds_read_b64_tr_b16 v[170:171], v30 offset:256
    s_waitcnt lgkmcnt(6)
    v_mfma_f32_32x32x16_bf16 v[144:159], v[180:183], a[152:155], v[144:159]
    ds_read_b64_tr_b16 v[172:173], v31 offset:0
    ds_read_b64_tr_b16 v[174:175], v31 offset:256
    s_waitcnt lgkmcnt(6)
    v_mfma_f32_32x32x16_bf16 v[128:143], v[160:163], a[156:159], v[128:143]
    buffer_load_dwordx4 a[196:199], v20, s[40:43], s22 offen offset:1024 sc1
    ds_read_b64_tr_b16 v[176:177], v30 offset:512
    ds_read_b64_tr_b16 v[178:179], v30 offset:768
    s_waitcnt lgkmcnt(6)
    v_mfma_f32_32x32x16_bf16 v[144:159], v[164:167], a[156:159], v[144:159]
    ds_read_b64_tr_b16 v[180:181], v31 offset:512
    ds_read_b64_tr_b16 v[182:183], v31 offset:768
    s_waitcnt vmcnt(9)
    s_waitcnt lgkmcnt(6)
    v_mfma_f32_32x32x16_bf16 v[128:143], v[168:171], a[160:163], v[128:143]
    buffer_load_dwordx4 a[200:203], v20, s[40:43], s22 offen offset:2048 sc1
    ds_read_b64_tr_b16 v[160:161], v30 offset:4096
    ds_read_b64_tr_b16 v[162:163], v30 offset:4352
    s_waitcnt lgkmcnt(6)
    v_mfma_f32_32x32x16_bf16 v[144:159], v[172:175], a[160:163], v[144:159]
    ds_read_b64_tr_b16 v[164:165], v31 offset:4096
    ds_read_b64_tr_b16 v[166:167], v31 offset:4352
    s_waitcnt vmcnt(9)
    s_waitcnt lgkmcnt(6)
    v_mfma_f32_32x32x16_bf16 v[128:143], v[176:179], a[164:167], v[128:143]
    buffer_load_dwordx4 a[204:207], v20, s[40:43], s22 offen offset:3072 sc1
    ds_read_b64_tr_b16 v[168:169], v30 offset:4608
    ds_read_b64_tr_b16 v[170:171], v30 offset:4864
    s_waitcnt lgkmcnt(6)
    v_mfma_f32_32x32x16_bf16 v[144:159], v[180:183], a[164:167], v[144:159]
    ds_read_b64_tr_b16 v[172:173], v31 offset:4608
    ds_read_b64_tr_b16 v[174:175], v31 offset:4864
    s_waitcnt vmcnt(9)
    s_waitcnt lgkmcnt(6)
    v_mfma_f32_32x32x16_bf16 v[128:143], v[160:163], a[168:171], v[128:143]
    buffer_load_dwordx4 a[208:211], v20, s[40:43], s23 offen offset:0 sc1
    ds_read_b64_tr_b16 v[176:177], v30 offset:16384
    ds_read_b64_tr_b16 v[178:179], v30 offset:16640
    s_waitcnt lgkmcnt(6)
    v_mfma_f32_32x32x16_bf16 v[144:159], v[164:167], a[168:171], v[144:159]
    ds_read_b64_tr_b16 v[180:181], v31 offset:16384
    ds_read_b64_tr_b16 v[182:183], v31 offset:16640
    s_waitcnt vmcnt(9)
    s_waitcnt lgkmcnt(6)
    v_mfma_f32_32x32x16_bf16 v[128:143], v[168:171], a[172:175], v[128:143]
    buffer_load_dwordx4 a[212:215], v20, s[40:43], s23 offen offset:1024 sc1
    ds_read_b64_tr_b16 v[160:161], v30 offset:16896
    ds_read_b64_tr_b16 v[162:163], v30 offset:17152
    s_waitcnt lgkmcnt(6)
    v_mfma_f32_32x32x16_bf16 v[144:159], v[172:175], a[172:175], v[144:159]
    ds_read_b64_tr_b16 v[164:165], v31 offset:16896
    ds_read_b64_tr_b16 v[166:167], v31 offset:17152
    s_waitcnt vmcnt(9)
    s_waitcnt lgkmcnt(6)
    v_mfma_f32_32x32x16_bf16 v[128:143], v[176:179], a[176:179], v[128:143]
    buffer_load_dwordx4 a[216:219], v20, s[40:43], s23 offen offset:2048 sc1
    ds_read_b64_tr_b16 v[168:169], v30 offset:20480
    ds_read_b64_tr_b16 v[170:171], v30 offset:20736
    s_waitcnt lgkmcnt(6)
    v_mfma_f32_32x32x16_bf16 v[144:159], v[180:183], a[176:179], v[144:159]
    ds_read_b64_tr_b16 v[172:173], v31 offset:20480
    ds_read_b64_tr_b16 v[174:175], v31 offset:20736
    s_waitcnt vmcnt(9)
    s_waitcnt lgkmcnt(6)
    v_mfma_f32_32x32x16_bf16 v[128:143], v[160:163], a[180:183], v[128:143]
    buffer_load_dwordx4 a[220:223], v20, s[40:43], s23 offen offset:3072 sc1
    ds_read_b64_tr_b16 v[176:177], v30 offset:20992
    ds_read_b64_tr_b16 v[178:179], v30 offset:21248
    s_waitcnt lgkmcnt(6)
    v_mfma_f32_32x32x16_bf16 v[144:159], v[164:167], a[180:183], v[144:159]
    ds_read_b64_tr_b16 v[180:181], v31 offset:20992
    ds_read_b64_tr_b16 v[182:183], v31 offset:21248
    s_waitcnt vmcnt(9)
    s_waitcnt lgkmcnt(6)
    v_mfma_f32_32x32x16_bf16 v[128:143], v[168:171], a[184:187], v[128:143]
    ds_read_b64_tr_b16 v[160:161], v30 offset:32768
    ds_read_b64_tr_b16 v[162:163], v30 offset:33024
    s_waitcnt lgkmcnt(6)
    v_mfma_f32_32x32x16_bf16 v[144:159], v[172:175], a[184:187], v[144:159]
    ds_read_b64_tr_b16 v[164:165], v31 offset:32768
    ds_read_b64_tr_b16 v[166:167], v31 offset:33024
    s_waitcnt vmcnt(8)
    s_waitcnt lgkmcnt(6)
    v_mfma_f32_32x32x16_bf16 v[128:143], v[176:179], a[188:191], v[128:143]
    ds_read_b64_tr_b16 v[168:169], v30 offset:33280
    ds_read_b64_tr_b16 v[170:171], v30 offset:33536
    s_waitcnt lgkmcnt(6)
    v_mfma_f32_32x32x16_bf16 v[144:159], v[180:183], a[188:191], v[144:159]
    ds_read_b64_tr_b16 v[172:173], v31 offset:33280
    ds_read_b64_tr_b16 v[174:175], v31 offset:33536
    s_waitcnt vmcnt(7)
    s_waitcnt lgkmcnt(6)
    v_mfma_f32_32x32x16_bf16 v[128:143], v[160:163], a[192:195], v[128:143]
    ds_read_b64_tr_b16 v[176:177], v30 offset:36864
    ds_read_b64_tr_b16 v[178:179], v30 offset:37120
    s_waitcnt lgkmcnt(6)
    v_mfma_f32_32x32x16_bf16 v[144:159], v[164:167], a[192:195], v[144:159]
    ds_read_b64_tr_b16 v[180:181], v31 offset:36864
    ds_read_b64_tr_b16 v[182:183], v31 offset:37120
    s_waitcnt vmcnt(6)
    s_waitcnt lgkmcnt(6)
    v_mfma_f32_32x32x16_bf16 v[128:143], v[168:171], a[196:199], v[128:143]
    ds_read_b64_tr_b16 v[160:161], v30 offset:37376
    ds_read_b64_tr_b16 v[162:163], v30 offset:37632
    s_waitcnt lgkmcnt(6)
    v_mfma_f32_32x32x16_bf16 v[144:159], v[172:175], a[196:199], v[144:159]
    ds_read_b64_tr_b16 v[164:165], v31 offset:37376
    ds_read_b64_tr_b16 v[166:167], v31 offset:37632
    s_waitcnt vmcnt(5)
    s_waitcnt lgkmcnt(6)
    v_mfma_f32_32x32x16_bf16 v[128:143], v[176:179], a[200:203], v[128:143]
    ds_read_b64_tr_b16 v[168:169], v31 offset:49152
    ds_read_b64_tr_b16 v[170:171], v31 offset:49408
    s_waitcnt lgkmcnt(6)
    v_mfma_f32_32x32x16_bf16 v[144:159], v[180:183], a[200:203], v[144:159]
    ds_read_b64_tr_b16 v[172:173], v31 offset:49664
    ds_read_b64_tr_b16 v[174:175], v31 offset:49920
    s_waitcnt vmcnt(4)
    s_waitcnt lgkmcnt(6)
    v_mfma_f32_32x32x16_bf16 v[128:143], v[160:163], a[204:207], v[128:143]
    ds_read_b64_tr_b16 v[176:177], v31 offset:53248
    ds_read_b64_tr_b16 v[178:179], v31 offset:53504
    s_waitcnt lgkmcnt(6)
    v_mfma_f32_32x32x16_bf16 v[144:159], v[164:167], a[204:207], v[144:159]
    ds_read_b64_tr_b16 v[180:181], v31 offset:53760
    ds_read_b64_tr_b16 v[182:183], v31 offset:54016
    s_waitcnt vmcnt(3)
    s_waitcnt lgkmcnt(6)
    v_mfma_f32_32x32x16_bf16 v[144:159], v[168:171], a[208:211], v[144:159]
    ds_read_b64_tr_b16 v[160:161], v30 offset:49152
    ds_read_b64_tr_b16 v[162:163], v30 offset:49408
    s_waitcnt vmcnt(2)
    s_waitcnt lgkmcnt(6)
    v_mfma_f32_32x32x16_bf16 v[144:159], v[172:175], a[212:215], v[144:159]
    ds_read_b64_tr_b16 v[164:165], v30 offset:49664
    ds_read_b64_tr_b16 v[166:167], v30 offset:49920
    s_waitcnt vmcnt(1)
    s_waitcnt lgkmcnt(6)
    v_mfma_f32_32x32x16_bf16 v[144:159], v[176:179], a[216:219], v[144:159]
    ds_read_b64_tr_b16 v[168:169], v30 offset:53248
    ds_read_b64_tr_b16 v[170:171], v30 offset:53504
    s_waitcnt vmcnt(0)
    s_waitcnt lgkmcnt(6)
    v_mfma_f32_32x32x16_bf16 v[144:159], v[180:183], a[220:223], v[144:159]
    ds_read_b64_tr_b16 v[172:173], v30 offset:53760
    ds_read_b64_tr_b16 v[174:175], v30 offset:54016
    v_xor_b32 v3, 4096, v22
    s_waitcnt lgkmcnt(6)
    v_mfma_f32_32x32x16_bf16 v[128:143], v[160:163], a[208:211], v[128:143]
    s_waitcnt lgkmcnt(4)
    v_mfma_f32_32x32x16_bf16 v[128:143], v[164:167], a[212:215], v[128:143]
    s_nop 4
    ds_write_b128 v22, v[144:147] offset:0
    ds_write_b128 v22, v[148:151] offset:1024
    ds_write_b128 v22, v[152:155] offset:2048
    ds_write_b128 v22, v[156:159] offset:3072
    s_waitcnt lgkmcnt(6)
    v_mfma_f32_32x32x16_bf16 v[128:143], v[168:171], a[216:219], v[128:143]
    s_waitcnt lgkmcnt(4)
    v_mfma_f32_32x32x16_bf16 v[128:143], v[172:175], a[220:223], v[128:143]
    s_waitcnt lgkmcnt(0)
    s_barrier
    ds_read_b128 v[184:187], v3 offset:0
    ds_read_b128 v[188:191], v3 offset:1024
    ds_read_b128 v[192:195], v3 offset:2048
    ds_read_b128 v[196:199], v3 offset:3072
    s_waitcnt lgkmcnt(3)
    s_nop 4
    v_pk_add_f32 v[128:129], v[128:129], v[184:185]
    v_pk_add_f32 v[130:131], v[130:131], v[186:187]
    v_cvt_pk_bf16_f32 v160, v128, v129
    v_cvt_pk_bf16_f32 v161, v130, v131
    s_waitcnt lgkmcnt(2)
    v_pk_add_f32 v[132:133], v[132:133], v[188:189]
    v_pk_add_f32 v[134:135], v[134:135], v[190:191]
    v_cvt_pk_bf16_f32 v162, v132, v133
    v_cvt_pk_bf16_f32 v163, v134, v135
    s_nop 0
    v_permlane32_swap_b32 v160, v162
    v_permlane32_swap_b32 v161, v163
    buffer_store_dwordx4 v[160:163], v23, s[44:47], 0 offen offset:0
    s_waitcnt lgkmcnt(1)
    v_pk_add_f32 v[136:137], v[136:137], v[192:193]
    v_pk_add_f32 v[138:139], v[138:139], v[194:195]
    v_cvt_pk_bf16_f32 v164, v136, v137
    v_cvt_pk_bf16_f32 v165, v138, v139
    s_waitcnt lgkmcnt(0)
    v_pk_add_f32 v[140:141], v[140:141], v[196:197]
    v_pk_add_f32 v[142:143], v[142:143], v[198:199]
    v_cvt_pk_bf16_f32 v166, v140, v141
    v_cvt_pk_bf16_f32 v167, v142, v143
    s_nop 0
    v_permlane32_swap_b32 v164, v166
    v_permlane32_swap_b32 v165, v167
    buffer_store_dwordx4 v[164:167], v23, s[44:47], 0 offen offset:32
L_end:
    s_endpgm
L_slowa:
    s_nop 15
    v_mov_b32 v240, v24
    v_mfma_f32_32x32x16_bf16 v[224:239], v[100:103], v[124:127], v[48:63]
    s_nop 11
    v_max3_f32 v240, v240, v224, v225
    v_max3_f32 v240, v240, v226, v227
    v_max3_f32 v240, v240, v228, v229
    v_max3_f32 v240, v240, v230, v231
    v_max3_f32 v240, v240, v232, v233
    v_max3_f32 v240, v240, v234, v235
    v_max3_f32 v240, v240, v236, v237
    v_max3_f32 v240, v240, v238, v239
    s_nop 15
L_sk1_0_0:
    v_mfma_f32_32x32x16_bf16 v[224:239], v[96:99], v[124:127], 0
    s_nop 11
    v_max3_f32 v240, v240, v224, v225
    v_max3_f32 v240, v240, v226, v227
    v_max3_f32 v240, v240, v228, v229
    v_max3_f32 v240, v240, v230, v231
    v_max3_f32 v240, v240, v232, v233
    v_max3_f32 v240, v240, v234, v235
    v_max3_f32 v240, v240, v236, v237
    v_max3_f32 v240, v240, v238, v239
    s_nop 15
L_sk1_0_1:
    s_cmp_lt_u32 s66, 1
    s_cbranch_scc1 L_sk1_0_2
    v_mfma_f32_32x32x16_bf16 v[224:239], a[0:3], v[124:127], 0
    s_nop 11
    v_max3_f32 v240, v240, v224, v225
    v_max3_f32 v240, v240, v226, v227
    v_max3_f32 v240, v240, v228, v229
    v_max3_f32 v240, v240, v230, v231
    v_max3_f32 v240, v240, v232, v233
    v_max3_f32 v240, v240, v234, v235
    v_max3_f32 v240, v240, v236, v237
    v_max3_f32 v240, v240, v238, v239
    s_nop 15
L_sk1_0_2:
    s_cmp_lt_u32 s66, 1
    s_cbranch_scc1 L_sk1_0_3
    v_mfma_f32_32x32x16_bf16 v[224:239], a[12:15], v[124:127], 0
    s_nop 11
    v_max3_f32 v240, v240, v224, v225
    v_max3_f32 v240, v240, v226, v227
    v_max3_f32 v240, v240, v228, v229
    v_max3_f32 v240, v240, v230, v231
    v_max3_f32 v240, v240, v232, v233
    v_max3_f32 v240, v240, v234, v235
    v_max3_f32 v240, v240, v236, v237
    v_max3_f32 v240, v240, v238, v239
    s_nop 15
L_sk1_0_3:
    s_cmp_lt_u32 s66, 2
    s_cbranch_scc1 L_sk1_0_4
    v_mfma_f32_32x32x16_bf16 v[224:239], a[24:27], v[124:127], 0
    s_nop 11
    v_max3_f32 v240, v240, v224, v225
    v_max3_f32 v240, v240, v226, v227
    v_max3_f32 v240, v240, v228, v229
    v_max3_f32 v240, v240, v230, v231
    v_max3_f32 v240, v240, v232, v233
    v_max3_f32 v240, v240, v234, v235
    v_max3_f32 v240, v240, v236, v237
    v_max3_f32 v240, v240, v238, v239
    s_nop 15
L_sk1_0_4:
    s_cmp_lt_u32 s66, 2
    s_cbranch_scc1 L_sk1_0_5
    v_mfma_f32_32x32x16_bf16 v[224:239], a[36:39], v[124:127], 0
    s_nop 11
    v_max3_f32 v240, v240, v224, v225
    v_max3_f32 v240, v240, v226, v227
    v_max3_f32 v240, v240, v228, v229
    v_max3_f32 v240, v240, v230, v231
    v_max3_f32 v240, v240, v232, v233
    v_max3_f32 v240, v240, v234, v235
    v_max3_f32 v240, v240, v236, v237
    v_max3_f32 v240, v240, v238, v239
    s_nop 15
L_sk1_0_5:
    s_cmp_lt_u32 s66, 3
    s_cbranch_scc1 L_sk1_0_6
    v_mfma_f32_32x32x16_bf16 v[224:239], a[48:51], v[124:127], 0
    s_nop 11
    v_max3_f32 v240, v240, v224, v225
    v_max3_f32 v240, v240, v226, v227
    v_max3_f32 v240, v240, v228, v229
    v_max3_f32 v240, v240, v230, v231
    v_max3_f32 v240, v240, v232, v233
    v_max3_f32 v240, v240, v234, v235
    v_max3_f32 v240, v240, v236, v237
    v_max3_f32 v240, v240, v238, v239
    s_nop 15
L_sk1_0_6:
    s_cmp_lt_u32 s66, 3
    s_cbranch_scc1 L_sk1_0_7
    v_mfma_f32_32x32x16_bf16 v[224:239], a[60:63], v[124:127], 0
    s_nop 11
    v_max3_f32 v240, v240, v224, v225
    v_max3_f32 v240, v240, v226, v227
    v_max3_f32 v240, v240, v228, v229
    v_max3_f32 v240, v240, v230, v231
    v_max3_f32 v240, v240, v232, v233
    v_max3_f32 v240, v240, v234, v235
    v_max3_f32 v240, v240, v236, v237
    v_max3_f32 v240, v240, v238, v239
    s_nop 15
L_sk1_0_7:
    s_cmp_lt_u32 s66, 4
    s_cbranch_scc1 L_sk1_0_8
    v_mfma_f32_32x32x16_bf16 v[224:239], a[72:75], v[124:127], v[64:79]
    s_nop 11
    v_max3_f32 v240, v240, v224, v225
    v_max3_f32 v240, v240, v226, v227
    v_max3_f32 v240, v240, v228, v229
    v_max3_f32 v240, v240, v230, v231
    v_max3_f32 v240, v240, v232, v233
    v_max3_f32 v240, v240, v234, v235
    v_max3_f32 v240, v240, v236, v237
    v_max3_f32 v240, v240, v238, v239
    s_nop 15
L_sk1_0_8:
    v_mov_b32 v241, v240
    s_nop 1
    v_permlane32_swap_b32 v240, v241
    v_max_f32 v240, v240, v241
    v_mfma_f32_32x32x16_bf16 v[224:239], v[100:103], v[124:127], v[48:63]
    s_nop 11
    v_sub_f32 v224, v224, v240
    v_sub_f32 v225, v225, v240
    v_sub_f32 v226, v226, v240
    v_sub_f32 v227, v227, v240
    v_sub_f32 v228, v228, v240
    v_sub_f32 v229, v229, v240
    v_sub_f32 v230, v230, v240
    v_sub_f32 v231, v231, v240
    v_sub_f32 v232, v232, v240
    v_sub_f32 v233, v233, v240
    v_sub_f32 v234, v234, v240
    v_sub_f32 v235, v235, v240
    v_sub_f32 v236, v236, v240
    v_sub_f32 v237, v237, v240
    v_sub_f32 v238, v238, v240
    v_sub_f32 v239, v239, v240
    v_exp_f32 v224, v224
    v_exp_f32 v225, v225
    v_exp_f32 v226, v226
    v_exp_f32 v227, v227
    v_exp_f32 v228, v228
    v_exp_f32 v229, v229
    v_exp_f32 v230, v230
    v_exp_f32 v231, v231
    v_exp_f32 v232, v232
    v_exp_f32 v233, v233
    v_exp_f32 v234, v234
    v_exp_f32 v235, v235
    v_exp_f32 v236, v236
    v_exp_f32 v237, v237
    v_exp_f32 v238, v238
    v_exp_f32 v239, v239
    v_cvt_pk_bf16_f32 v244, v224, v225
    v_cvt_pk_bf16_f32 v245, v226, v227
    v_cvt_pk_bf16_f32 v246, v228, v229
    v_cvt_pk_bf16_f32 v247, v230, v231
    v_cvt_pk_bf16_f32 v248, v232, v233
    v_cvt_pk_bf16_f32 v249, v234, v235
    v_cvt_pk_bf16_f32 v250, v236, v237
    v_cvt_pk_bf16_f32 v251, v238, v239
    v_mfma_f32_32x32x16_bf16 v[152:167], v[112:115], v[244:247], 0
    s_nop 0
    v_mfma_f32_32x32x16_bf16 v[152:167], v[116:119], v[248:251], v[152:167]
    s_nop 15
L_sk1_1_0:
    v_mfma_f32_32x32x16_bf16 v[224:239], v[96:99], v[124:127], 0
    s_nop 11
    v_sub_f32 v224, v224, v240
    v_sub_f32 v225, v225, v240
    v_sub_f32 v226, v226, v240
    v_sub_f32 v227, v227, v240
    v_sub_f32 v228, v228, v240
    v_sub_f32 v229, v229, v240
    v_sub_f32 v230, v230, v240
    v_sub_f32 v231, v231, v240
    v_sub_f32 v232, v232, v240
    v_sub_f32 v233, v233, v240
    v_sub_f32 v234, v234, v240
    v_sub_f32 v235, v235, v240
    v_sub_f32 v236, v236, v240
    v_sub_f32 v237, v237, v240
    v_sub_f32 v238, v238, v240
    v_sub_f32 v239, v239, v240
    v_exp_f32 v224, v224
    v_exp_f32 v225, v225
    v_exp_f32 v226, v226
    v_exp_f32 v227, v227
    v_exp_f32 v228, v228
    v_exp_f32 v229, v229
    v_exp_f32 v230, v230
    v_exp_f32 v231, v231
    v_exp_f32 v232, v232
    v_exp_f32 v233, v233
    v_exp_f32 v234, v234
    v_exp_f32 v235, v235
    v_exp_f32 v236, v236
    v_exp_f32 v237, v237
    v_exp_f32 v238, v238
    v_exp_f32 v239, v239
    v_cvt_pk_bf16_f32 v244, v224, v225
    v_cvt_pk_bf16_f32 v245, v226, v227
    v_cvt_pk_bf16_f32 v246, v228, v229
    v_cvt_pk_bf16_f32 v247, v230, v231
    v_cvt_pk_bf16_f32 v248, v232, v233
    v_cvt_pk_bf16_f32 v249, v234, v235
    v_cvt_pk_bf16_f32 v250, v236, v237
    v_cvt_pk_bf16_f32 v251, v238, v239
    v_mfma_f32_32x32x16_bf16 v[152:167], v[104:107], v[244:247], v[152:167]
    s_nop 0
    v_mfma_f32_32x32x16_bf16 v[152:167], v[108:111], v[248:251], v[152:167]
    s_nop 15
L_sk1_1_1:
    s_cmp_lt_u32 s66, 1
    s_cbranch_scc1 L_sk1_1_2
    v_mfma_f32_32x32x16_bf16 v[224:239], a[0:3], v[124:127], 0
    s_nop 11
    v_sub_f32 v224, v224, v240
    v_sub_f32 v225, v225, v240
    v_sub_f32 v226, v226, v240
    v_sub_f32 v227, v227, v240
    v_sub_f32 v228, v228, v240
    v_sub_f32 v229, v229, v240
    v_sub_f32 v230, v230, v240
    v_sub_f32 v231, v231, v240
    v_sub_f32 v232, v232, v240
    v_sub_f32 v233, v233, v240
    v_sub_f32 v234, v234, v240
    v_sub_f32 v235, v235, v240
    v_sub_f32 v236, v236, v240
    v_sub_f32 v237, v237, v240
    v_sub_f32 v238, v238, v240
    v_sub_f32 v239, v239, v240
    v_exp_f32 v224, v224
    v_exp_f32 v225, v225
    v_exp_f32 v226, v226
    v_exp_f32 v227, v227
    v_exp_f32 v228, v228
    v_exp_f32 v229, v229
    v_exp_f32 v230, v230
    v_exp_f32 v231, v231
    v_exp_f32 v232, v232
    v_exp_f32 v233, v233
    v_exp_f32 v234, v234
    v_exp_f32 v235, v235
    v_exp_f32 v236, v236
    v_exp_f32 v237, v237
    v_exp_f32 v238, v238
    v_exp_f32 v239, v239
    v_cvt_pk_bf16_f32 v244, v224, v225
    v_cvt_pk_bf16_f32 v245, v226, v227
    v_cvt_pk_bf16_f32 v246, v228, v229
    v_cvt_pk_bf16_f32 v247, v230, v231
    v_cvt_pk_bf16_f32 v248, v232, v233
    v_cvt_pk_bf16_f32 v249, v234, v235
    v_cvt_pk_bf16_f32 v250, v236, v237
    v_cvt_pk_bf16_f32 v251, v238, v239
    v_mfma_f32_32x32x16_bf16 v[152:167], a[4:7], v[244:247], v[152:167]
    s_nop 0
    v_mfma_f32_32x32x16_bf16 v[152:167], a[8:11], v[248:251], v[152:167]
    s_nop 15
L_sk1_1_2:
    s_cmp_lt_u32 s66, 1
    s_cbranch_scc1 L_sk1_1_3
    v_mfma_f32_32x32x16_bf16 v[224:239], a[12:15], v[124:127], 0
    s_nop 11
    v_sub_f32 v224, v224, v240
    v_sub_f32 v225, v225, v240
    v_sub_f32 v226, v226, v240
    v_sub_f32 v227, v227, v240
    v_sub_f32 v228, v228, v240
    v_sub_f32 v229, v229, v240
    v_sub_f32 v230, v230, v240
    v_sub_f32 v231, v231, v240
    v_sub_f32 v232, v232, v240
    v_sub_f32 v233, v233, v240
    v_sub_f32 v234, v234, v240
    v_sub_f32 v235, v235, v240
    v_sub_f32 v236, v236, v240
    v_sub_f32 v237, v237, v240
    v_sub_f32 v238, v238, v240
    v_sub_f32 v239, v239, v240
    v_exp_f32 v224, v224
    v_exp_f32 v225, v225
    v_exp_f32 v226, v226
    v_exp_f32 v227, v227
    v_exp_f32 v228, v228
    v_exp_f32 v229, v229
    v_exp_f32 v230, v230
    v_exp_f32 v231, v231
    v_exp_f32 v232, v232
    v_exp_f32 v233, v233
    v_exp_f32 v234, v234
    v_exp_f32 v235, v235
    v_exp_f32 v236, v236
    v_exp_f32 v237, v237
    v_exp_f32 v238, v238
    v_exp_f32 v239, v239
    v_cvt_pk_bf16_f32 v244, v224, v225
    v_cvt_pk_bf16_f32 v245, v226, v227
    v_cvt_pk_bf16_f32 v246, v228, v229
    v_cvt_pk_bf16_f32 v247, v230, v231
    v_cvt_pk_bf16_f32 v248, v232, v233
    v_cvt_pk_bf16_f32 v249, v234, v235
    v_cvt_pk_bf16_f32 v250, v236, v237
    v_cvt_pk_bf16_f32 v251, v238, v239
    v_mfma_f32_32x32x16_bf16 v[152:167], a[16:19], v[244:247], v[152:167]
    s_nop 0
    v_mfma_f32_32x32x16_bf16 v[152:167], a[20:23], v[248:251], v[152:167]
    s_nop 15
L_sk1_1_3:
    s_cmp_lt_u32 s66, 2
    s_cbranch_scc1 L_sk1_1_4
    v_mfma_f32_32x32x16_bf16 v[224:239], a[24:27], v[124:127], 0
    s_nop 11
    v_sub_f32 v224, v224, v240
    v_sub_f32 v225, v225, v240
    v_sub_f32 v226, v226, v240
    v_sub_f32 v227, v227, v240
    v_sub_f32 v228, v228, v240
    v_sub_f32 v229, v229, v240
    v_sub_f32 v230, v230, v240
    v_sub_f32 v231, v231, v240
    v_sub_f32 v232, v232, v240
    v_sub_f32 v233, v233, v240
    v_sub_f32 v234, v234, v240
    v_sub_f32 v235, v235, v240
    v_sub_f32 v236, v236, v240
    v_sub_f32 v237, v237, v240
    v_sub_f32 v238, v238, v240
    v_sub_f32 v239, v239, v240
    v_exp_f32 v224, v224
    v_exp_f32 v225, v225
    v_exp_f32 v226, v226
    v_exp_f32 v227, v227
    v_exp_f32 v228, v228
    v_exp_f32 v229, v229
    v_exp_f32 v230, v230
    v_exp_f32 v231, v231
    v_exp_f32 v232, v232
    v_exp_f32 v233, v233
    v_exp_f32 v234, v234
    v_exp_f32 v235, v235
    v_exp_f32 v236, v236
    v_exp_f32 v237, v237
    v_exp_f32 v238, v238
    v_exp_f32 v239, v239
    v_cvt_pk_bf16_f32 v244, v224, v225
    v_cvt_pk_bf16_f32 v245, v226, v227
    v_cvt_pk_bf16_f32 v246, v228, v229
    v_cvt_pk_bf16_f32 v247, v230, v231
    v_cvt_pk_bf16_f32 v248, v232, v233
    v_cvt_pk_bf16_f32 v249, v234, v235
    v_cvt_pk_bf16_f32 v250, v236, v237
    v_cvt_pk_bf16_f32 v251, v238, v239
    v_mfma_f32_32x32x16_bf16 v[152:167], a[28:31], v[244:247], v[152:167]
    s_nop 0
    v_mfma_f32_32x32x16_bf16 v[152:167], a[32:35], v[248:251], v[152:167]
    s_nop 15
L_sk1_1_4:
    s_cmp_lt_u32 s66, 2
    s_cbranch_scc1 L_sk1_1_5
    v_mfma_f32_32x32x16_bf16 v[224:239], a[36:39], v[124:127], 0
    s_nop 11
    v_sub_f32 v224, v224, v240
    v_sub_f32 v225, v225, v240
    v_sub_f32 v226, v226, v240
    v_sub_f32 v227, v227, v240
    v_sub_f32 v228, v228, v240
    v_sub_f32 v229, v229, v240
    v_sub_f32 v230, v230, v240
    v_sub_f32 v231, v231, v240
    v_sub_f32 v232, v232, v240
    v_sub_f32 v233, v233, v240
    v_sub_f32 v234, v234, v240
    v_sub_f32 v235, v235, v240
    v_sub_f32 v236, v236, v240
    v_sub_f32 v237, v237, v240
    v_sub_f32 v238, v238, v240
    v_sub_f32 v239, v239, v240
    v_exp_f32 v224, v224
    v_exp_f32 v225, v225
    v_exp_f32 v226, v226
    v_exp_f32 v227, v227
    v_exp_f32 v228, v228
    v_exp_f32 v229, v229
    v_exp_f32 v230, v230
    v_exp_f32 v231, v231
    v_exp_f32 v232, v232
    v_exp_f32 v233, v233
    v_exp_f32 v234, v234
    v_exp_f32 v235, v235
    v_exp_f32 v236, v236
    v_exp_f32 v237, v237
    v_exp_f32 v238, v238
    v_exp_f32 v239, v239
    v_cvt_pk_bf16_f32 v244, v224, v225
    v_cvt_pk_bf16_f32 v245, v226, v227
    v_cvt_pk_bf16_f32 v246, v228, v229
    v_cvt_pk_bf16_f32 v247, v230, v231
    v_cvt_pk_bf16_f32 v248, v232, v233
    v_cvt_pk_bf16_f32 v249, v234, v235
    v_cvt_pk_bf16_f32 v250, v236, v237
    v_cvt_pk_bf16_f32 v251, v238, v239
    v_mfma_f32_32x32x16_bf16 v[152:167], a[40:43], v[244:247], v[152:167]
    s_nop 0
    v_mfma_f32_32x32x16_bf16 v[152:167], a[44:47], v[248:251], v[152:167]
    s_nop 15
L_sk1_1_5:
    s_cmp_lt_u32 s66, 3
    s_cbranch_scc1 L_sk1_1_6
    v_mfma_f32_32x32x16_bf16 v[224:239], a[48:51], v[124:127], 0
    s_nop 11
    v_sub_f32 v224, v224, v240
    v_sub_f32 v225, v225, v240
    v_sub_f32 v226, v226, v240
    v_sub_f32 v227, v227, v240
    v_sub_f32 v228, v228, v240
    v_sub_f32 v229, v229, v240
    v_sub_f32 v230, v230, v240
    v_sub_f32 v231, v231, v240
    v_sub_f32 v232, v232, v240
    v_sub_f32 v233, v233, v240
    v_sub_f32 v234, v234, v240
    v_sub_f32 v235, v235, v240
    v_sub_f32 v236, v236, v240
    v_sub_f32 v237, v237, v240
    v_sub_f32 v238, v238, v240
    v_sub_f32 v239, v239, v240
    v_exp_f32 v224, v224
    v_exp_f32 v225, v225
    v_exp_f32 v226, v226
    v_exp_f32 v227, v227
    v_exp_f32 v228, v228
    v_exp_f32 v229, v229
    v_exp_f32 v230, v230
    v_exp_f32 v231, v231
    v_exp_f32 v232, v232
    v_exp_f32 v233, v233
    v_exp_f32 v234, v234
    v_exp_f32 v235, v235
    v_exp_f32 v236, v236
    v_exp_f32 v237, v237
    v_exp_f32 v238, v238
    v_exp_f32 v239, v239
    v_cvt_pk_bf16_f32 v244, v224, v225
    v_cvt_pk_bf16_f32 v245, v226, v227
    v_cvt_pk_bf16_f32 v246, v228, v229
    v_cvt_pk_bf16_f32 v247, v230, v231
    v_cvt_pk_bf16_f32 v248, v232, v233
    v_cvt_pk_bf16_f32 v249, v234, v235
    v_cvt_pk_bf16_f32 v250, v236, v237
    v_cvt_pk_bf16_f32 v251, v238, v239
    v_mfma_f32_32x32x16_bf16 v[152:167], a[52:55], v[244:247], v[152:167]
    s_nop 0
    v_mfma_f32_32x32x16_bf16 v[152:167], a[56:59], v[248:251], v[152:167]
    s_nop 15
L_sk1_1_6:
    s_cmp_lt_u32 s66, 3
    s_cbranch_scc1 L_sk1_1_7
    v_mfma_f32_32x32x16_bf16 v[224:239], a[60:63], v[124:127], 0
    s_nop 11
    v_sub_f32 v224, v224, v240
    v_sub_f32 v225, v225, v240
    v_sub_f32 v226, v226, v240
    v_sub_f32 v227, v227, v240
    v_sub_f32 v228, v228, v240
    v_sub_f32 v229, v229, v240
    v_sub_f32 v230, v230, v240
    v_sub_f32 v231, v231, v240
    v_sub_f32 v232, v232, v240
    v_sub_f32 v233, v233, v240
    v_sub_f32 v234, v234, v240
    v_sub_f32 v235, v235, v240
    v_sub_f32 v236, v236, v240
    v_sub_f32 v237, v237, v240
    v_sub_f32 v238, v238, v240
    v_sub_f32 v239, v239, v240
    v_exp_f32 v224, v224
    v_exp_f32 v225, v225
    v_exp_f32 v226, v226
    v_exp_f32 v227, v227
    v_exp_f32 v228, v228
    v_exp_f32 v229, v229
    v_exp_f32 v230, v230
    v_exp_f32 v231, v231
    v_exp_f32 v232, v232
    v_exp_f32 v233, v233
    v_exp_f32 v234, v234
    v_exp_f32 v235, v235
    v_exp_f32 v236, v236
    v_exp_f32 v237, v237
    v_exp_f32 v238, v238
    v_exp_f32 v239, v239
    v_cvt_pk_bf16_f32 v244, v224, v225
    v_cvt_pk_bf16_f32 v245, v226, v227
    v_cvt_pk_bf16_f32 v246, v228, v229
    v_cvt_pk_bf16_f32 v247, v230, v231
    v_cvt_pk_bf16_f32 v248, v232, v233
    v_cvt_pk_bf16_f32 v249, v234, v235
    v_cvt_pk_bf16_f32 v250, v236, v237
    v_cvt_pk_bf16_f32 v251, v238, v239
    v_mfma_f32_32x32x16_bf16 v[152:167], a[64:67], v[244:247], v[152:167]
    s_nop 0
    v_mfma_f32_32x32x16_bf16 v[152:167], a[68:71], v[248:251], v[152:167]
    s_nop 15
L_sk1_1_7:
    s_cmp_lt_u32 s66, 4
    s_cbranch_scc1 L_sk1_1_8
    v_mfma_f32_32x32x16_bf16 v[224:239], a[72:75], v[124:127], v[64:79]
    s_nop 11
    v_sub_f32 v224, v224, v240
    v_sub_f32 v225, v225, v240
    v_sub_f32 v226, v226, v240
    v_sub_f32 v227, v227, v240
    v_sub_f32 v228, v228, v240
    v_sub_f32 v229, v229, v240
    v_sub_f32 v230, v230, v240
    v_sub_f32 v231, v231, v240
    v_sub_f32 v232, v232, v240
    v_sub_f32 v233, v233, v240
    v_sub_f32 v234, v234, v240
    v_sub_f32 v235, v235, v240
    v_sub_f32 v236, v236, v240
    v_sub_f32 v237, v237, v240
    v_sub_f32 v238, v238, v240
    v_sub_f32 v239, v239, v240
    v_exp_f32 v224, v224
    v_exp_f32 v225, v225
    v_exp_f32 v226, v226
    v_exp_f32 v227, v227
    v_exp_f32 v228, v228
    v_exp_f32 v229, v229
    v_exp_f32 v230, v230
    v_exp_f32 v231, v231
    v_exp_f32 v232, v232
    v_exp_f32 v233, v233
    v_exp_f32 v234, v234
    v_exp_f32 v235, v235
    v_exp_f32 v236, v236
    v_exp_f32 v237, v237
    v_exp_f32 v238, v238
    v_exp_f32 v239, v239
    v_cvt_pk_bf16_f32 v244, v224, v225
    v_cvt_pk_bf16_f32 v245, v226, v227
    v_cvt_pk_bf16_f32 v246, v228, v229
    v_cvt_pk_bf16_f32 v247, v230, v231
    v_cvt_pk_bf16_f32 v248, v232, v233
    v_cvt_pk_bf16_f32 v249, v234, v235
    v_cvt_pk_bf16_f32 v250, v236, v237
    v_cvt_pk_bf16_f32 v251, v238, v239
    v_mfma_f32_32x32x16_bf16 v[152:167], a[76:79], v[244:247], v[152:167]
    s_nop 0
    v_mfma_f32_32x32x16_bf16 v[152:167], a[80:83], v[248:251], v[152:167]
    s_nop 15
L_sk1_1_8:
    v_rcp_f32 v161, v160
    s_nop 0
    v_mul_f32 v164, v161, v43
    v_pk_mul_f32 v[152:153], v[152:153], v[164:165] op_sel_hi:[1,0]
    v_pk_mul_f32 v[154:155], v[154:155], v[164:165] op_sel_hi:[1,0]
    v_pk_mul_f32 v[156:157], v[156:157], v[164:165] op_sel_hi:[1,0]
    v_pk_mul_f32 v[158:159], v[158:159], v[164:165] op_sel_hi:[1,0]
    v_cvt_pk_bf16_f32 v208, v152, v153
    v_cvt_pk_bf16_f32 v209, v154, v155
    v_cvt_pk_bf16_f32 v210, v156, v157
    v_cvt_pk_bf16_f32 v211, v158, v159
    v_mov_b32 v240, v24
    v_mfma_f32_32x32x16_bf16 v[224:239], v[96:99], v[120:123], v[48:63]
    s_nop 11
    v_max3_f32 v240, v240, v224, v225
    v_max3_f32 v240, v240, v226, v227
    v_max3_f32 v240, v240, v228, v229
    v_max3_f32 v240, v240, v230, v231
    v_max3_f32 v240, v240, v232, v233
    v_max3_f32 v240, v240, v234, v235
    v_max3_f32 v240, v240, v236, v237
    v_max3_f32 v240, v240, v238, v239
    s_nop 15
L_sk0_0_0:
    s_cmp_lt_u32 s66, 1
    s_cbranch_scc1 L_sk0_0_1
    v_mfma_f32_32x32x16_bf16 v[224:239], a[0:3], v[120:123], 0
    s_nop 11
    v_max3_f32 v240, v240, v224, v225
    v_max3_f32 v240, v240, v226, v227
    v_max3_f32 v240, v240, v228, v229
    v_max3_f32 v240, v240, v230, v231
    v_max3_f32 v240, v240, v232, v233
    v_max3_f32 v240, v240, v234, v235
    v_max3_f32 v240, v240, v236, v237
    v_max3_f32 v240, v240, v238, v239
    s_nop 15
L_sk0_0_1:
    s_cmp_lt_u32 s66, 1
    s_cbranch_scc1 L_sk0_0_2
    v_mfma_f32_32x32x16_bf16 v[224:239], a[12:15], v[120:123], 0
    s_nop 11
    v_max3_f32 v240, v240, v224, v225
    v_max3_f32 v240, v240, v226, v227
    v_max3_f32 v240, v240, v228, v229
    v_max3_f32 v240, v240, v230, v231
    v_max3_f32 v240, v240, v232, v233
    v_max3_f32 v240, v240, v234, v235
    v_max3_f32 v240, v240, v236, v237
    v_max3_f32 v240, v240, v238, v239
    s_nop 15
L_sk0_0_2:
    s_cmp_lt_u32 s66, 2
    s_cbranch_scc1 L_sk0_0_3
    v_mfma_f32_32x32x16_bf16 v[224:239], a[24:27], v[120:123], 0
    s_nop 11
    v_max3_f32 v240, v240, v224, v225
    v_max3_f32 v240, v240, v226, v227
    v_max3_f32 v240, v240, v228, v229
    v_max3_f32 v240, v240, v230, v231
    v_max3_f32 v240, v240, v232, v233
    v_max3_f32 v240, v240, v234, v235
    v_max3_f32 v240, v240, v236, v237
    v_max3_f32 v240, v240, v238, v239
    s_nop 15
L_sk0_0_3:
    s_cmp_lt_u32 s66, 2
    s_cbranch_scc1 L_sk0_0_4
    v_mfma_f32_32x32x16_bf16 v[224:239], a[36:39], v[120:123], 0
    s_nop 11
    v_max3_f32 v240, v240, v224, v225
    v_max3_f32 v240, v240, v226, v227
    v_max3_f32 v240, v240, v228, v229
    v_max3_f32 v240, v240, v230, v231
    v_max3_f32 v240, v240, v232, v233
    v_max3_f32 v240, v240, v234, v235
    v_max3_f32 v240, v240, v236, v237
    v_max3_f32 v240, v240, v238, v239
    s_nop 15
L_sk0_0_4:
    s_cmp_lt_u32 s66, 3
    s_cbranch_scc1 L_sk0_0_5
    v_mfma_f32_32x32x16_bf16 v[224:239], a[48:51], v[120:123], 0
    s_nop 11
    v_max3_f32 v240, v240, v224, v225
    v_max3_f32 v240, v240, v226, v227
    v_max3_f32 v240, v240, v228, v229
    v_max3_f32 v240, v240, v230, v231
    v_max3_f32 v240, v240, v232, v233
    v_max3_f32 v240, v240, v234, v235
    v_max3_f32 v240, v240, v236, v237
    v_max3_f32 v240, v240, v238, v239
    s_nop 15
L_sk0_0_5:
    s_cmp_lt_u32 s66, 3
    s_cbranch_scc1 L_sk0_0_6
    v_mfma_f32_32x32x16_bf16 v[224:239], a[60:63], v[120:123], 0
    s_nop 11
    v_max3_f32 v240, v240, v224, v225
    v_max3_f32 v240, v240, v226, v227
    v_max3_f32 v240, v240, v228, v229
    v_max3_f32 v240, v240, v230, v231
    v_max3_f32 v240, v240, v232, v233
    v_max3_f32 v240, v240, v234, v235
    v_max3_f32 v240, v240, v236, v237
    v_max3_f32 v240, v240, v238, v239
    s_nop 15
L_sk0_0_6:
    s_cmp_lt_u32 s66, 4
    s_cbranch_scc1 L_sk0_0_7
    v_mfma_f32_32x32x16_bf16 v[224:239], a[72:75], v[120:123], 0
    s_nop 11
    v_max3_f32 v240, v240, v224, v225
    v_max3_f32 v240, v240, v226, v227
    v_max3_f32 v240, v240, v228, v229
    v_max3_f32 v240, v240, v230, v231
    v_max3_f32 v240, v240, v232, v233
    v_max3_f32 v240, v240, v234, v235
    v_max3_f32 v240, v240, v236, v237
    v_max3_f32 v240, v240, v238, v239
    s_nop 15
L_sk0_0_7:
    s_cmp_lt_u32 s66, 4
    s_cbranch_scc1 L_sk0_0_8
    v_mfma_f32_32x32x16_bf16 v[224:239], a[84:87], v[120:123], v[64:79]
    s_nop 11
    v_max3_f32 v240, v240, v224, v225
    v_max3_f32 v240, v240, v226, v227
    v_max3_f32 v240, v240, v228, v229
    v_max3_f32 v240, v240, v230, v231
    v_max3_f32 v240, v240, v232, v233
    v_max3_f32 v240, v240, v234, v235
    v_max3_f32 v240, v240, v236, v237
    v_max3_f32 v240, v240, v238, v239
    s_nop 15
L_sk0_0_8:
    v_mov_b32 v241, v240
    s_nop 1
    v_permlane32_swap_b32 v240, v241
    v_max_f32 v240, v240, v241
    v_mfma_f32_32x32x16_bf16 v[224:239], v[96:99], v[120:123], v[48:63]
    s_nop 11
    v_sub_f32 v224, v224, v240
    v_sub_f32 v225, v225, v240
    v_sub_f32 v226, v226, v240
    v_sub_f32 v227, v227, v240
    v_sub_f32 v228, v228, v240
    v_sub_f32 v229, v229, v240
    v_sub_f32 v230, v230, v240
    v_sub_f32 v231, v231, v240
    v_sub_f32 v232, v232, v240
    v_sub_f32 v233, v233, v240
    v_sub_f32 v234, v234, v240
    v_sub_f32 v235, v235, v240
    v_sub_f32 v236, v236, v240
    v_sub_f32 v237, v237, v240
    v_sub_f32 v238, v238, v240
    v_sub_f32 v239, v239, v240
    v_exp_f32 v224, v224
    v_exp_f32 v225, v225
    v_exp_f32 v226, v226
    v_exp_f32 v227, v227
    v_exp_f32 v228, v228
    v_exp_f32 v229, v229
    v_exp_f32 v230, v230
    v_exp_f32 v231, v231
    v_exp_f32 v232, v232
    v_exp_f32 v233, v233
    v_exp_f32 v234, v234
    v_exp_f32 v235, v235
    v_exp_f32 v236, v236
    v_exp_f32 v237, v237
    v_exp_f32 v238, v238
    v_exp_f32 v239, v239
    v_cvt_pk_bf16_f32 v244, v224, v225
    v_cvt_pk_bf16_f32 v245, v226, v227
    v_cvt_pk_bf16_f32 v246, v228, v229
    v_cvt_pk_bf16_f32 v247, v230, v231
    v_cvt_pk_bf16_f32 v248, v232, v233
    v_cvt_pk_bf16_f32 v249, v234, v235
    v_cvt_pk_bf16_f32 v250, v236, v237
    v_cvt_pk_bf16_f32 v251, v238, v239
    v_mfma_f32_32x32x16_bf16 v[136:151], v[104:107], v[244:247], 0
    s_nop 0
    v_mfma_f32_32x32x16_bf16 v[136:151], v[108:111], v[248:251], v[136:151]
    s_nop 15
L_sk0_1_0:
    s_cmp_lt_u32 s66, 1
    s_cbranch_scc1 L_sk0_1_1
    v_mfma_f32_32x32x16_bf16 v[224:239], a[0:3], v[120:123], 0
    s_nop 11
    v_sub_f32 v224, v224, v240
    v_sub_f32 v225, v225, v240
    v_sub_f32 v226, v226, v240
    v_sub_f32 v227, v227, v240
    v_sub_f32 v228, v228, v240
    v_sub_f32 v229, v229, v240
    v_sub_f32 v230, v230, v240
    v_sub_f32 v231, v231, v240
    v_sub_f32 v232, v232, v240
    v_sub_f32 v233, v233, v240
    v_sub_f32 v234, v234, v240
    v_sub_f32 v235, v235, v240
    v_sub_f32 v236, v236, v240
    v_sub_f32 v237, v237, v240
    v_sub_f32 v238, v238, v240
    v_sub_f32 v239, v239, v240
    v_exp_f32 v224, v224
    v_exp_f32 v225, v225
    v_exp_f32 v226, v226
    v_exp_f32 v227, v227
    v_exp_f32 v228, v228
    v_exp_f32 v229, v229
    v_exp_f32 v230, v230
    v_exp_f32 v231, v231
    v_exp_f32 v232, v232
    v_exp_f32 v233, v233
    v_exp_f32 v234, v234
    v_exp_f32 v235, v235
    v_exp_f32 v236, v236
    v_exp_f32 v237, v237
    v_exp_f32 v238, v238
    v_exp_f32 v239, v239
    v_cvt_pk_bf16_f32 v244, v224, v225
    v_cvt_pk_bf16_f32 v245, v226, v227
    v_cvt_pk_bf16_f32 v246, v228, v229
    v_cvt_pk_bf16_f32 v247, v230, v231
    v_cvt_pk_bf16_f32 v248, v232, v233
    v_cvt_pk_bf16_f32 v249, v234, v235
    v_cvt_pk_bf16_f32 v250, v236, v237
    v_cvt_pk_bf16_f32 v251, v238, v239
    v_mfma_f32_32x32x16_bf16 v[136:151], a[4:7], v[244:247], v[136:151]
    s_nop 0
    v_mfma_f32_32x32x16_bf16 v[136:151], a[8:11], v[248:251], v[136:151]
    s_nop 15
L_sk0_1_1:
    s_cmp_lt_u32 s66, 1
    s_cbranch_scc1 L_sk0_1_2
    v_mfma_f32_32x32x16_bf16 v[224:239], a[12:15], v[120:123], 0
    s_nop 11
    v_sub_f32 v224, v224, v240
    v_sub_f32 v225, v225, v240
    v_sub_f32 v226, v226, v240
    v_sub_f32 v227, v227, v240
    v_sub_f32 v228, v228, v240
    v_sub_f32 v229, v229, v240
    v_sub_f32 v230, v230, v240
    v_sub_f32 v231, v231, v240
    v_sub_f32 v232, v232, v240
    v_sub_f32 v233, v233, v240
    v_sub_f32 v234, v234, v240
    v_sub_f32 v235, v235, v240
    v_sub_f32 v236, v236, v240
    v_sub_f32 v237, v237, v240
    v_sub_f32 v238, v238, v240
    v_sub_f32 v239, v239, v240
    v_exp_f32 v224, v224
    v_exp_f32 v225, v225
    v_exp_f32 v226, v226
    v_exp_f32 v227, v227
    v_exp_f32 v228, v228
    v_exp_f32 v229, v229
    v_exp_f32 v230, v230
    v_exp_f32 v231, v231
    v_exp_f32 v232, v232
    v_exp_f32 v233, v233
    v_exp_f32 v234, v234
    v_exp_f32 v235, v235
    v_exp_f32 v236, v236
    v_exp_f32 v237, v237
    v_exp_f32 v238, v238
    v_exp_f32 v239, v239
    v_cvt_pk_bf16_f32 v244, v224, v225
    v_cvt_pk_bf16_f32 v245, v226, v227
    v_cvt_pk_bf16_f32 v246, v228, v229
    v_cvt_pk_bf16_f32 v247, v230, v231
    v_cvt_pk_bf16_f32 v248, v232, v233
    v_cvt_pk_bf16_f32 v249, v234, v235
    v_cvt_pk_bf16_f32 v250, v236, v237
    v_cvt_pk_bf16_f32 v251, v238, v239
    v_mfma_f32_32x32x16_bf16 v[136:151], a[16:19], v[244:247], v[136:151]
    s_nop 0
    v_mfma_f32_32x32x16_bf16 v[136:151], a[20:23], v[248:251], v[136:151]
    s_nop 15
L_sk0_1_2:
    s_cmp_lt_u32 s66, 2
    s_cbranch_scc1 L_sk0_1_3
    v_mfma_f32_32x32x16_bf16 v[224:239], a[24:27], v[120:123], 0
    s_nop 11
    v_sub_f32 v224, v224, v240
    v_sub_f32 v225, v225, v240
    v_sub_f32 v226, v226, v240
    v_sub_f32 v227, v227, v240
    v_sub_f32 v228, v228, v240
    v_sub_f32 v229, v229, v240
    v_sub_f32 v230, v230, v240
    v_sub_f32 v231, v231, v240
    v_sub_f32 v232, v232, v240
    v_sub_f32 v233, v233, v240
    v_sub_f32 v234, v234, v240
    v_sub_f32 v235, v235, v240
    v_sub_f32 v236, v236, v240
    v_sub_f32 v237, v237, v240
    v_sub_f32 v238, v238, v240
    v_sub_f32 v239, v239, v240
    v_exp_f32 v224, v224
    v_exp_f32 v225, v225
    v_exp_f32 v226, v226
    v_exp_f32 v227, v227
    v_exp_f32 v228, v228
    v_exp_f32 v229, v229
    v_exp_f32 v230, v230
    v_exp_f32 v231, v231
    v_exp_f32 v232, v232
    v_exp_f32 v233, v233
    v_exp_f32 v234, v234
    v_exp_f32 v235, v235
    v_exp_f32 v236, v236
    v_exp_f32 v237, v237
    v_exp_f32 v238, v238
    v_exp_f32 v239, v239
    v_cvt_pk_bf16_f32 v244, v224, v225
    v_cvt_pk_bf16_f32 v245, v226, v227
    v_cvt_pk_bf16_f32 v246, v228, v229
    v_cvt_pk_bf16_f32 v247, v230, v231
    v_cvt_pk_bf16_f32 v248, v232, v233
    v_cvt_pk_bf16_f32 v249, v234, v235
    v_cvt_pk_bf16_f32 v250, v236, v237
    v_cvt_pk_bf16_f32 v251, v238, v239
    v_mfma_f32_32x32x16_bf16 v[136:151], a[28:31], v[244:247], v[136:151]
    s_nop 0
    v_mfma_f32_32x32x16_bf16 v[136:151], a[32:35], v[248:251], v[136:151]
    s_nop 15
L_sk0_1_3:
    s_cmp_lt_u32 s66, 2
    s_cbranch_scc1 L_sk0_1_4
    v_mfma_f32_32x32x16_bf16 v[224:239], a[36:39], v[120:123], 0
    s_nop 11
    v_sub_f32 v224, v224, v240
    v_sub_f32 v225, v225, v240
    v_sub_f32 v226, v226, v240
    v_sub_f32 v227, v227, v240
    v_sub_f32 v228, v228, v240
    v_sub_f32 v229, v229, v240
    v_sub_f32 v230, v230, v240
    v_sub_f32 v231, v231, v240
    v_sub_f32 v232, v232, v240
    v_sub_f32 v233, v233, v240
    v_sub_f32 v234, v234, v240
    v_sub_f32 v235, v235, v240
    v_sub_f32 v236, v236, v240
    v_sub_f32 v237, v237, v240
    v_sub_f32 v238, v238, v240
    v_sub_f32 v239, v239, v240
    v_exp_f32 v224, v224
    v_exp_f32 v225, v225
    v_exp_f32 v226, v226
    v_exp_f32 v227, v227
    v_exp_f32 v228, v228
    v_exp_f32 v229, v229
    v_exp_f32 v230, v230
    v_exp_f32 v231, v231
    v_exp_f32 v232, v232
    v_exp_f32 v233, v233
    v_exp_f32 v234, v234
    v_exp_f32 v235, v235
    v_exp_f32 v236, v236
    v_exp_f32 v237, v237
    v_exp_f32 v238, v238
    v_exp_f32 v239, v239
    v_cvt_pk_bf16_f32 v244, v224, v225
    v_cvt_pk_bf16_f32 v245, v226, v227
    v_cvt_pk_bf16_f32 v246, v228, v229
    v_cvt_pk_bf16_f32 v247, v230, v231
    v_cvt_pk_bf16_f32 v248, v232, v233
    v_cvt_pk_bf16_f32 v249, v234, v235
    v_cvt_pk_bf16_f32 v250, v236, v237
    v_cvt_pk_bf16_f32 v251, v238, v239
    v_mfma_f32_32x32x16_bf16 v[136:151], a[40:43], v[244:247], v[136:151]
    s_nop 0
    v_mfma_f32_32x32x16_bf16 v[136:151], a[44:47], v[248:251], v[136:151]
    s_nop 15
L_sk0_1_4:
    s_cmp_lt_u32 s66, 3
    s_cbranch_scc1 L_sk0_1_5
    v_mfma_f32_32x32x16_bf16 v[224:239], a[48:51], v[120:123], 0
    s_nop 11
    v_sub_f32 v224, v224, v240
    v_sub_f32 v225, v225, v240
    v_sub_f32 v226, v226, v240
    v_sub_f32 v227, v227, v240
    v_sub_f32 v228, v228, v240
    v_sub_f32 v229, v229, v240
    v_sub_f32 v230, v230, v240
    v_sub_f32 v231, v231, v240
    v_sub_f32 v232, v232, v240
    v_sub_f32 v233, v233, v240
    v_sub_f32 v234, v234, v240
    v_sub_f32 v235, v235, v240
    v_sub_f32 v236, v236, v240
    v_sub_f32 v237, v237, v240
    v_sub_f32 v238, v238, v240
    v_sub_f32 v239, v239, v240
    v_exp_f32 v224, v224
    v_exp_f32 v225, v225
    v_exp_f32 v226, v226
    v_exp_f32 v227, v227
    v_exp_f32 v228, v228
    v_exp_f32 v229, v229
    v_exp_f32 v230, v230
    v_exp_f32 v231, v231
    v_exp_f32 v232, v232
    v_exp_f32 v233, v233
    v_exp_f32 v234, v234
    v_exp_f32 v235, v235
    v_exp_f32 v236, v236
    v_exp_f32 v237, v237
    v_exp_f32 v238, v238
    v_exp_f32 v239, v239
    v_cvt_pk_bf16_f32 v244, v224, v225
    v_cvt_pk_bf16_f32 v245, v226, v227
    v_cvt_pk_bf16_f32 v246, v228, v229
    v_cvt_pk_bf16_f32 v247, v230, v231
    v_cvt_pk_bf16_f32 v248, v232, v233
    v_cvt_pk_bf16_f32 v249, v234, v235
    v_cvt_pk_bf16_f32 v250, v236, v237
    v_cvt_pk_bf16_f32 v251, v238, v239
    v_mfma_f32_32x32x16_bf16 v[136:151], a[52:55], v[244:247], v[136:151]
    s_nop 0
    v_mfma_f32_32x32x16_bf16 v[136:151], a[56:59], v[248:251], v[136:151]
    s_nop 15
L_sk0_1_5:
    s_cmp_lt_u32 s66, 3
    s_cbranch_scc1 L_sk0_1_6
    v_mfma_f32_32x32x16_bf16 v[224:239], a[60:63], v[120:123], 0
    s_nop 11
    v_sub_f32 v224, v224, v240
    v_sub_f32 v225, v225, v240
    v_sub_f32 v226, v226, v240
    v_sub_f32 v227, v227, v240
    v_sub_f32 v228, v228, v240
    v_sub_f32 v229, v229, v240
    v_sub_f32 v230, v230, v240
    v_sub_f32 v231, v231, v240
    v_sub_f32 v232, v232, v240
    v_sub_f32 v233, v233, v240
    v_sub_f32 v234, v234, v240
    v_sub_f32 v235, v235, v240
    v_sub_f32 v236, v236, v240
    v_sub_f32 v237, v237, v240
    v_sub_f32 v238, v238, v240
    v_sub_f32 v239, v239, v240
    v_exp_f32 v224, v224
    v_exp_f32 v225, v225
    v_exp_f32 v226, v226
    v_exp_f32 v227, v227
    v_exp_f32 v228, v228
    v_exp_f32 v229, v229
    v_exp_f32 v230, v230
    v_exp_f32 v231, v231
    v_exp_f32 v232, v232
    v_exp_f32 v233, v233
    v_exp_f32 v234, v234
    v_exp_f32 v235, v235
    v_exp_f32 v236, v236
    v_exp_f32 v237, v237
    v_exp_f32 v238, v238
    v_exp_f32 v239, v239
    v_cvt_pk_bf16_f32 v244, v224, v225
    v_cvt_pk_bf16_f32 v245, v226, v227
    v_cvt_pk_bf16_f32 v246, v228, v229
    v_cvt_pk_bf16_f32 v247, v230, v231
    v_cvt_pk_bf16_f32 v248, v232, v233
    v_cvt_pk_bf16_f32 v249, v234, v235
    v_cvt_pk_bf16_f32 v250, v236, v237
    v_cvt_pk_bf16_f32 v251, v238, v239
    v_mfma_f32_32x32x16_bf16 v[136:151], a[64:67], v[244:247], v[136:151]
    s_nop 0
    v_mfma_f32_32x32x16_bf16 v[136:151], a[68:71], v[248:251], v[136:151]
    s_nop 15
L_sk0_1_6:
    s_cmp_lt_u32 s66, 4
    s_cbranch_scc1 L_sk0_1_7
    v_mfma_f32_32x32x16_bf16 v[224:239], a[72:75], v[120:123], 0
    s_nop 11
    v_sub_f32 v224, v224, v240
    v_sub_f32 v225, v225, v240
    v_sub_f32 v226, v226, v240
    v_sub_f32 v227, v227, v240
    v_sub_f32 v228, v228, v240
    v_sub_f32 v229, v229, v240
    v_sub_f32 v230, v230, v240
    v_sub_f32 v231, v231, v240
    v_sub_f32 v232, v232, v240
    v_sub_f32 v233, v233, v240
    v_sub_f32 v234, v234, v240
    v_sub_f32 v235, v235, v240
    v_sub_f32 v236, v236, v240
    v_sub_f32 v237, v237, v240
    v_sub_f32 v238, v238, v240
    v_sub_f32 v239, v239, v240
    v_exp_f32 v224, v224
    v_exp_f32 v225, v225
    v_exp_f32 v226, v226
    v_exp_f32 v227, v227
    v_exp_f32 v228, v228
    v_exp_f32 v229, v229
    v_exp_f32 v230, v230
    v_exp_f32 v231, v231
    v_exp_f32 v232, v232
    v_exp_f32 v233, v233
    v_exp_f32 v234, v234
    v_exp_f32 v235, v235
    v_exp_f32 v236, v236
    v_exp_f32 v237, v237
    v_exp_f32 v238, v238
    v_exp_f32 v239, v239
    v_cvt_pk_bf16_f32 v244, v224, v225
    v_cvt_pk_bf16_f32 v245, v226, v227
    v_cvt_pk_bf16_f32 v246, v228, v229
    v_cvt_pk_bf16_f32 v247, v230, v231
    v_cvt_pk_bf16_f32 v248, v232, v233
    v_cvt_pk_bf16_f32 v249, v234, v235
    v_cvt_pk_bf16_f32 v250, v236, v237
    v_cvt_pk_bf16_f32 v251, v238, v239
    v_mfma_f32_32x32x16_bf16 v[136:151], a[76:79], v[244:247], v[136:151]
    s_nop 0
    v_mfma_f32_32x32x16_bf16 v[136:151], a[80:83], v[248:251], v[136:151]
    s_nop 15
L_sk0_1_7:
    s_cmp_lt_u32 s66, 4
    s_cbranch_scc1 L_sk0_1_8
    v_mfma_f32_32x32x16_bf16 v[224:239], a[84:87], v[120:123], v[64:79]
    s_nop 11
    v_sub_f32 v224, v224, v240
    v_sub_f32 v225, v225, v240
    v_sub_f32 v226, v226, v240
    v_sub_f32 v227, v227, v240
    v_sub_f32 v228, v228, v240
    v_sub_f32 v229, v229, v240
    v_sub_f32 v230, v230, v240
    v_sub_f32 v231, v231, v240
    v_sub_f32 v232, v232, v240
    v_sub_f32 v233, v233, v240
    v_sub_f32 v234, v234, v240
    v_sub_f32 v235, v235, v240
    v_sub_f32 v236, v236, v240
    v_sub_f32 v237, v237, v240
    v_sub_f32 v238, v238, v240
    v_sub_f32 v239, v239, v240
    v_exp_f32 v224, v224
    v_exp_f32 v225, v225
    v_exp_f32 v226, v226
    v_exp_f32 v227, v227
    v_exp_f32 v228, v228
    v_exp_f32 v229, v229
    v_exp_f32 v230, v230
    v_exp_f32 v231, v231
    v_exp_f32 v232, v232
    v_exp_f32 v233, v233
    v_exp_f32 v234, v234
    v_exp_f32 v235, v235
    v_exp_f32 v236, v236
    v_exp_f32 v237, v237
    v_exp_f32 v238, v238
    v_exp_f32 v239, v239
    v_cvt_pk_bf16_f32 v244, v224, v225
    v_cvt_pk_bf16_f32 v245, v226, v227
    v_cvt_pk_bf16_f32 v246, v228, v229
    v_cvt_pk_bf16_f32 v247, v230, v231
    v_cvt_pk_bf16_f32 v248, v232, v233
    v_cvt_pk_bf16_f32 v249, v234, v235
    v_cvt_pk_bf16_f32 v250, v236, v237
    v_cvt_pk_bf16_f32 v251, v238, v239
    v_mfma_f32_32x32x16_bf16 v[136:151], a[88:91], v[244:247], v[136:151]
    s_nop 0
    v_mfma_f32_32x32x16_bf16 v[136:151], a[92:95], v[248:251], v[136:151]
    s_nop 15
L_sk0_1_8:
    v_rcp_f32 v145, v144
    s_nop 0
    v_mul_f32 v148, v145, v42
    v_pk_mul_f32 v[136:137], v[136:137], v[148:149] op_sel_hi:[1,0]
    v_pk_mul_f32 v[138:139], v[138:139], v[148:149] op_sel_hi:[1,0]
    v_pk_mul_f32 v[140:141], v[140:141], v[148:149] op_sel_hi:[1,0]
    v_pk_mul_f32 v[142:143], v[142:143], v[148:149] op_sel_hi:[1,0]
    v_cvt_pk_bf16_f32 v204, v136, v137
    v_cvt_pk_bf16_f32 v205, v138, v139
    v_cvt_pk_bf16_f32 v206, v140, v141
    v_cvt_pk_bf16_f32 v207, v142, v143
    s_nop 3
    s_branch L_backa
L_slowb:
    s_nop 15
    v_mfma_f32_16x16x16_bf16 v[224:227], v[144:145], v[128:129], v[88:91]
    v_mfma_f32_16x16x16_bf16 v[228:231], v[136:137], v[128:129], v[80:83]
    v_mfma_f32_16x16x16_bf16 v[232:235], v[144:145], v[130:131], v[92:95]
    v_mfma_f32_16x16x16_bf16 v[236:239], v[138:139], v[130:131], v[80:83]
    v_mfma_f32_16x16x16_bf16 v[240:243], v[136:137], v[132:133], v[84:87]
    v_mfma_f32_16x16x16_bf16 v[244:247], v[140:141], v[132:133], v[80:83]
    v_mfma_f32_16x16x16_bf16 v[248:251], v[138:139], v[134:135], v[84:87]
    v_mfma_f32_16x16x16_bf16 v[252:255], v[142:143], v[134:135], v[80:83]
    s_nop 0
    v_max3_f32 v158, v224, v225, v226
    v_max3_f32 v162, v227, v228, v229
    v_max3_f32 v158, v158, v230, v231
    v_max_f32 v158, v158, v162
    v_max3_f32 v159, v232, v233, v234
    v_max3_f32 v163, v235, v236, v237
    v_max3_f32 v159, v159, v238, v239
    v_max_f32 v159, v159, v163
    v_max3_f32 v160, v240, v241, v242
    v_max3_f32 v164, v243, v244, v245
    v_max3_f32 v160, v160, v246, v247
    v_max_f32 v160, v160, v164
    v_max3_f32 v161, v248, v249, v250
    v_max3_f32 v165, v251, v252, v253
    v_max3_f32 v161, v161, v254, v255
    v_max_f32 v161, v161, v165
    v_mov_b32 v162, v158
    s_nop 1
    v_permlane16_swap_b32 v158, v162
    v_max_f32 v158, v158, v162
    v_mov_b32 v163, v159
    s_nop 1
    v_permlane16_swap_b32 v159, v163
    v_max_f32 v159, v159, v163
    v_mov_b32 v164, v160
    s_nop 1
    v_permlane16_swap_b32 v160, v164
    v_max_f32 v160, v160, v164
    v_mov_b32 v165, v161
    s_nop 1
    v_permlane16_swap_b32 v161, v165
    v_max_f32 v161, v161, v165
    v_mov_b32 v162, v158
    s_nop 1
    v_permlane32_swap_b32 v158, v162
    v_max_f32 v158, v158, v162
    v_mov_b32 v163, v159
    s_nop 1
    v_permlane32_swap_b32 v159, v163
    v_max_f32 v159, v159, v163
    v_mov_b32 v164, v160
    s_nop 1
    v_permlane32_swap_b32 v160, v164
    v_max_f32 v160, v160, v164
    v_mov_b32 v165, v161
    s_nop 1
    v_permlane32_swap_b32 v161, v165
    v_max_f32 v161, v161, v165
    v_sub_f32 v224, v224, v158
    v_sub_f32 v225, v225, v158
    v_sub_f32 v226, v226, v158
    v_sub_f32 v227, v227, v158
    v_sub_f32 v228, v228, v158
    v_sub_f32 v229, v229, v158
    v_sub_f32 v230, v230, v158
    v_sub_f32 v231, v231, v158
    v_exp_f32 v224, v224
    v_exp_f32 v225, v225
    v_exp_f32 v226, v226
    v_exp_f32 v227, v227
    v_cvt_pk_bf16_f32 v204, v224, v225
    v_exp_f32 v228, v228
    v_exp_f32 v229, v229
    v_cvt_pk_bf16_f32 v205, v226, v227
    v_exp_f32 v230, v230
    v_exp_f32 v231, v231
    v_cvt_pk_bf16_f32 v206, v228, v229
    v_cvt_pk_bf16_f32 v207, v230, v231
    s_nop 1
    v_mfma_f32_16x16x32_bf16 v[184:187], v[6:9], v[204:207], 0
    v_mfma_f32_16x16x32_bf16 v[168:171], v[146:149], v[204:207], 0
    v_sub_f32 v232, v232, v159
    v_sub_f32 v233, v233, v159
    v_sub_f32 v234, v234, v159
    v_sub_f32 v235, v235, v159
    v_sub_f32 v236, v236, v159
    v_sub_f32 v237, v237, v159
    v_sub_f32 v238, v238, v159
    v_sub_f32 v239, v239, v159
    v_exp_f32 v232, v232
    v_exp_f32 v233, v233
    v_exp_f32 v234, v234
    v_exp_f32 v235, v235
    v_cvt_pk_bf16_f32 v208, v232, v233
    v_exp_f32 v236, v236
    v_exp_f32 v237, v237
    v_cvt_pk_bf16_f32 v209, v234, v235
    v_exp_f32 v238, v238
    v_exp_f32 v239, v239
    v_cvt_pk_bf16_f32 v210, v236, v237
    v_cvt_pk_bf16_f32 v211, v238, v239
    s_nop 1
    v_mfma_f32_16x16x32_bf16 v[188:191], v[6:9], v[208:211], 0
    v_mfma_f32_16x16x32_bf16 v[172:175], v[152:155], v[208:211], 0
    v_sub_f32 v240, v240, v160
    v_sub_f32 v241, v241, v160
    v_sub_f32 v242, v242, v160
    v_sub_f32 v243, v243, v160
    v_sub_f32 v244, v244, v160
    v_sub_f32 v245, v245, v160
    v_sub_f32 v246, v246, v160
    v_sub_f32 v247, v247, v160
    v_exp_f32 v240, v240
    v_exp_f32 v241, v241
    v_exp_f32 v242, v242
    v_exp_f32 v243, v243
    v_cvt_pk_bf16_f32 v212, v240, v241
    v_exp_f32 v244, v244
    v_exp_f32 v245, v245
    v_cvt_pk_bf16_f32 v213, v242, v243
    v_exp_f32 v246, v246
    v_exp_f32 v247, v247
    v_cvt_pk_bf16_f32 v214, v244, v245
    v_cvt_pk_bf16_f32 v215, v246, v247
    s_nop 1
    v_mfma_f32_16x16x32_bf16 v[192:195], v[6:9], v[212:215], 0
    v_mfma_f32_16x16x32_bf16 v[176:179], v[148:151], v[212:215], 0
    v_sub_f32 v248, v248, v161
    v_sub_f32 v249, v249, v161
    v_sub_f32 v250, v250, v161
    v_sub_f32 v251, v251, v161
    v_sub_f32 v252, v252, v161
    v_sub_f32 v253, v253, v161
    v_sub_f32 v254, v254, v161
    v_sub_f32 v255, v255, v161
    v_exp_f32 v248, v248
    v_exp_f32 v249, v249
    v_exp_f32 v250, v250
    v_exp_f32 v251, v251
    v_cvt_pk_bf16_f32 v216, v248, v249
    v_exp_f32 v252, v252
    v_exp_f32 v253, v253
    v_cvt_pk_bf16_f32 v217, v250, v251
    v_exp_f32 v254, v254
    v_exp_f32 v255, v255
    v_cvt_pk_bf16_f32 v218, v252, v253
    v_cvt_pk_bf16_f32 v219, v254, v255
    s_nop 1
    v_mfma_f32_16x16x32_bf16 v[196:199], v[6:9], v[216:219], 0
    v_mfma_f32_16x16x32_bf16 v[180:183], v[154:157], v[216:219], 0
    v_rcp_f32 v158, v184
    v_rcp_f32 v159, v188
    v_rcp_f32 v160, v192
    s_nop 3
    v_rcp_f32 v161, v196
    s_nop 3
    s_branch L_backb
L_nonr:
    buffer_load_dwordx2 v[34:35], off, s[24:27], 0 sc1
    s_add_u32 s75, s75, 1
    s_cmp_lt_u32 s75, 200000
    s_waitcnt vmcnt(0)
    s_cbranch_scc1 L_non
    s_branch L_nonok
L_h1r:
    s_buffer_load_dwordx8 s[4:11], s[40:43], s12 glc
    s_add_u32 s75, s75, 1
    s_cmp_lt_u32 s75, 200000
    s_waitcnt lgkmcnt(0)
    s_cbranch_scc1 L_h1
    s_branch L_h1ok
L_pbr:
    s_buffer_load_dwordx16 s[4:19], s[40:43], s74 glc
    s_add_u32 s75, s75, 1
    s_cmp_lt_u32 s75, 200000
    s_waitcnt lgkmcnt(0)
    s_cbranch_scc1 L_pb
    s_branch L_pbok
L_par:
    s_buffer_load_dwordx16 s[4:19], s[40:43], s73 glc
    s_add_u32 s75, s75, 1
    s_cmp_lt_u32 s75, 200000
    s_waitcnt lgkmcnt(0)
    s_cbranch_scc1 L_pa
    s_branch L_paok
L_codeend:
.section .rodata,"a"
.p2align 6
.amdhsa_kernel gated_mix__sliding_block__sliding_local_dilated__prompt_kernel
  .amdhsa_next_free_vgpr 512
  .amdhsa_next_free_sgpr 102
  .amdhsa_accum_offset 256
  .amdhsa_group_segment_fixed_size 0
  .amdhsa_kernarg_size 80
  .amdhsa_user_sgpr_count 2
  .amdhsa_user_sgpr_kernarg_segment_ptr 1
  .amdhsa_system_sgpr_workgroup_id_x 1
.end_amdhsa_kernel
```
